```python
import torch

def _softmax(x, axis=-1):
    return torch.softmax(x, dim=axis)
def _gelu(x):
    return torch.nn.functional.gelu(x, approximate="tanh")
def _silu(x):
    return torch.nn.functional.silu(x)
def _sigmoid(x):
    return torch.sigmoid(x)
def _layernorm(x, axis=-1, eps=1e-5):
    m = x.mean(dim=axis, keepdim=True)
    v = x.var(dim=axis, keepdim=True, unbiased=False)
    return (x - m) / torch.sqrt(v + eps)
def _scatter_add(tgt, idx, src, axis=0):
    return tgt.clone().index_add_(axis, idx, src)
def _segment_sum(src, seg, n):
    out = torch.zeros((n,) + src.shape[1:], dtype=src.dtype)
    return out.index_add_(0, seg, src)
def _pad(x, pw):
    flat = tuple(v for pair in reversed(pw) for v in pair)
    return torch.nn.functional.pad(x, flat)

kernel_name = 'concat_heads__linear_attn_block__sliding_local_dilated__prompt'

def setup_inputs():

    _w = (lambda a: (lambda t: t.to(torch.bfloat16) if t.is_floating_point() else t)(torch.as_tensor(a)))
    def _A_setup():
        B, S, D = 1, 2048, 448
        return {
            "x": _w((lambda *s: torch.randn(*s, dtype=torch.bfloat16) * 0.05)(B, S, D)),
            "wqkv": _w((lambda *s: torch.randn(*s, dtype=torch.bfloat16) * 1.6)(D, 3 * D)),
            "wo": _w((lambda *s: torch.randn(*s, dtype=torch.bfloat16) * 0.8)(D, D)),
        }
    _A_in = _A_setup()

    def _B_setup():
        B, S, D = 1, 2048, 448
        return {
            "x": _w((lambda *s: torch.randn(*s, dtype=torch.bfloat16) * 0.2)(B, S, D)),
            "wqkv": _w((lambda *s: torch.randn(*s, dtype=torch.bfloat16) * 0.2)(D, 3 * D)),
            "wo": _w((lambda *s: torch.randn(*s, dtype=torch.bfloat16) * 0.05)(D, D)),
        }
    _B_in = _B_setup()

    return {
        "A_x": _A_in["x"],
        "A_wqkv": _A_in["wqkv"],
        "A_wo": _A_in["wo"],
        "B_x": _B_in["x"],
        "B_wqkv": _B_in["wqkv"],
        "B_wo": _B_in["wo"],
    }

def reference(A_x, A_wqkv, A_wo, B_x, B_wqkv, B_wo):
    def _A_ref(x, wqkv, wo):
        B, S, D = x.shape
        H = 16; Dh = D // H
        qkv = (lambda x, *d: x.permute(*d))((x @ wqkv).reshape(B, S, 3, H, Dh), 2, 0, 3, 1, 4)
        q, k, v = qkv[0], qkv[1], qkv[2]
        phi = lambda t: torch.where(t > 0, t + 1, torch.exp(t)) + 1e-6
        pq, pk = phi(q), phi(k)
        kv = torch.einsum("bhsd,bhse->bhde", pk, v)
        z = torch.einsum("bhsd->bhd", pk)
        num = torch.einsum("bhqd,bhde->bhqe", pq, kv)
        den = torch.einsum("bhqd,bhd->bhq", pq, z)[..., None] + 1e-6
        o = num / den
        return (lambda x, *d: x.permute(*d))(o, 0, 2, 1, 3).reshape(B, S, D) @ wo

    def _B_ref(x, wqkv, wo):
        B, S, D = x.shape
        H = 16; Dh = D // H
        W, dil = 8, 2
        qkv = (lambda x, *d: x.permute(*d))((x @ wqkv).reshape(B, S, 3, H, Dh), 2, 0, 3, 1, 4)
        q, k, v = qkv[0], qkv[1], qkv[2]
        scale = Dh ** -0.5
        pos = torch.arange(S)
        off = torch.arange(W) * dil
        idx = pos[:, None] - off[None, :]
        mask = idx >= 0
        idx_c = torch.where(mask, idx, 0).reshape(-1)
        kg = k[:, :, idx_c, :].reshape(B, H, S, W, Dh)
        vg = v[:, :, idx_c, :].reshape(B, H, S, W, Dh)
        logits = torch.einsum("bhsd,bhswd->bhsw", q, kg) * scale
        logits = torch.where(mask[None, None, :, :], logits, -1e9)
        attn = _softmax(logits, axis=-1)
        o = torch.einsum("bhsw,bhswd->bhsd", attn, vg)
        return (lambda x, *d: x.permute(*d))(o, 0, 2, 1, 3).reshape(B, S, D) @ wo

    a = _A_ref(A_x, A_wqkv, A_wo)
    b = _B_ref(B_x, B_wqkv, B_wo)
    return torch.concatenate([a, b], axis=-1)
```

```asm
; @launch kernel=concat_heads__linear_attn_block__sliding_local_dilated__prompt_kernel grid=(256,1,1) block=(512,1,1) lds=163840
.amdgcn_target "amdgcn-amd-amdhsa--gfx950"
.text
.p2align 8
.globl concat_heads__linear_attn_block__sliding_local_dilated__prompt_kernel
.type concat_heads__linear_attn_block__sliding_local_dilated__prompt_kernel,@function
concat_heads__linear_attn_block__sliding_local_dilated__prompt_kernel:
    s_cmp_ge_u32 s2, 256
    s_cbranch_scc1 K_END
    s_getpc_b64 s[92:93]
    v_lshrrev_b32 v1, 6, v0
    s_andn2_b32 s29, s2, 7
    v_add_lshl_u32 v2, s29, v1, 7
    v_min_u32 v2, K_END-concat_heads__linear_attn_block__sliding_local_dilated__prompt_kernel-16, v2
    global_load_dword v253, v2, s[92:93]
    s_memrealtime s[86:87]
    s_getreg_b32 s88, hwreg(HW_REG_XCC_ID)
    s_and_b32 s88, s88, 15
    s_mov_b32 s95, s2
    s_mov_b32 s96, 0
    s_mov_b32 s97, 0
RESTART:
    s_and_b32 s24, s2, 1
    s_mul_i32 s29, s24, 24
    s_add_u32 s30, s0, s29
    s_addc_u32 s31, s1, 0
    s_load_dwordx4 s[4:7], s[30:31], 0
    s_load_dwordx2 s[8:9], s[0:1], 64
    s_load_dwordx2 s[10:11], s[30:31], 16
    s_load_dwordx2 s[80:81], s[0:1], 48
    v_lshrrev_b32 v1, 6, v0
    s_bfe_u32 s25, s2, 0x20001
    v_readfirstlane_b32 s27, v1
    s_lshl_b32 s25, s25, 2
    s_bfe_u32 s26, s2, 0x20003
    s_add_u32 s25, s25, s26
    s_lshr_b32 s26, s2, 5
    s_lshl_b32 s28, s25, 7
    s_mov_b32 s89, 0
    v_and_b32 v5, 63, v0
    v_lshlrev_b32 v13, 4, v5
    v_and_b32 v16, 15, v0
    v_bfe_u32 v17, v0, 4, 2
    s_and_b32 s38, s27, 3
    s_cmp_lt_u32 s27, 4
    s_cbranch_scc1 CW_PRO
    s_lshl_b32 s34, s25, 1
    s_add_u32 s34, s34, s26
    s_mul_i32 s30, s34, 37
    s_lshr_b32 s30, s30, 8
    s_mul_i32 s30, s30, 7
    s_sub_u32 s34, s34, s30
    s_cmp_eq_u32 s24, 0
    s_cbranch_scc1 LD_ND
    s_sleep 14
LD_ND:
    s_setprio 2
    v_lshrrev_b32 v6, 3, v5
    v_and_b32 v7, 7, v5
    s_lshl_b32 s29, s24, 2
    s_or_b32 s29, s29, s38
    s_cmp_eq_u32 s29, 3
    s_cselect_b32 s31, 1, 0
    s_lshl_b32 s29, s38, 2
    s_sub_u32 s29, s29, s31
    s_lshl_b32 s52, s29, 10
    s_lshl_b32 s30, s24, 1
    s_sub_u32 s29, s29, s30
    s_lshl_b32 s29, s29, 3
    s_add_u32 s29, s29, s28
    s_lshl_b32 s31, s31, 2
    v_xor_b32 v7, v7, v17
    v_xor_b32 v7, s31, v7
    v_add_u32 v6, s29, v6
    v_mul_i32_i24 v6, 896, v6
    v_lshl_add_u32 v20, v7, 4, v6
    v_xor_b32 v7, 4, v7
    v_lshl_add_u32 v21, v7, 4, v6
    v_add_u32 v21, 7168, v21
    v_add_u32 v22, 14336, v20
    v_add_u32 v23, 14336, v21
    s_lshl_b32 s35, s34, 7
    s_waitcnt lgkmcnt(0)
    s_mov_b32 s12, s4
    s_and_b32 s13, s5, 0xffff
    s_mov_b32 s14, 1835008
    s_mov_b32 s15, 0x00020000
    s_mov_b32 m0, s52
    s_add_u32 s53, s52, 1024
    buffer_load_dwordx4 v20, s[12:15], s35 offen lds
    s_mov_b32 m0, s53
    s_add_u32 s54, s52, 2048
    buffer_load_dwordx4 v21, s[12:15], s35 offen lds
    s_mov_b32 m0, s54
    s_add_u32 s55, s52, 3072
    buffer_load_dwordx4 v22, s[12:15], s35 offen lds
    s_mov_b32 m0, s55
    s_add_u32 s56, s52, 4096
    buffer_load_dwordx4 v23, s[12:15], s35 offen lds
    s_mul_i32 s32, s26, 112
    v_mov_b32 v47, 0x7fff0000
    s_add_u32 s42, s32, 896
    s_lshl_b32 s58, s38, 10
    s_lshl_b32 s43, s38, 6
    s_cmp_eq_u32 s24, 0
    s_cselect_b32 s42, s42, s32
    s_cselect_b32 s41, 14, 22
    s_mov_b32 s40, 0xba2e8bb
    s_cselect_b32 s40, 0x12492493, s40
    s_movk_i32 s30, 18432
    s_cselect_b32 s30, 16384, s30
    s_movk_i32 s39, 11264
    s_cselect_b32 s39, 7168, s39
    s_add_u32 s58, s58, s30
    v_add_u32 v40, s43, v5
    v_mul_hi_u32 v41, v40, s40
    v_mul_u32_u24 v42, s41, v41
    v_sub_u32 v42, v40, v42
    v_mul_u32_u24 v43, 37, v42
    v_lshrrev_b32 v43, 8, v43
    v_cmp_eq_u32 vcc, 21, v42
    v_bfe_u32 v45, v41, 2, 2
    v_bfe_u32 v46, v41, 4, 1
    v_and_b32 v41, 35, v41
    v_lshl_add_u32 v41, v45, 3, v41
    v_lshl_add_u32 v41, v46, 2, v41
    v_mul_u32_u24 v26, 2688, v41
    v_mul_u32_u24 v43, 784, v43
    v_add3_u32 v26, v26, v43, s42
    v_lshl_add_u32 v26, v42, 4, v26
    v_cndmask_b32 v26, v26, v47, vcc
    v_add_u32 v27, 86016, v26
    s_mul_i32 s36, s34, 172032
    s_mov_b32 s16, s6
    s_and_b32 s17, s7, 0xffff
    s_mov_b32 s18, 1204224
    s_mov_b32 s19, 0x00020000
    s_mov_b32 m0, s58
    s_add_u32 s59, s58, s39
    buffer_load_dwordx4 v26, s[16:19], s36 offen lds
    s_mov_b32 m0, s59
    s_lshl_b32 s30, 256, s24
    buffer_load_dwordx4 v27, s[16:19], s36 offen lds
    v_add_u32 v24, 28672, v20
    v_add_u32 v25, 28672, v21
    s_add_u32 s57, s52, 5120
    s_cmp_eq_u32 s24, 0
    s_cselect_b64 vcc, -1, 0
    s_cselect_b32 s57, 92160, s57
    v_cndmask_b32 v25, v25, v47, vcc
    s_cmp_eq_u32 s38, 3
    s_cselect_b32 s44, s12, s16
    s_cselect_b32 s45, s13, s17
    s_cselect_b32 s46, s14, s18
    s_cselect_b32 s47, s15, s19
    s_cselect_b32 s37, s35, s36
    s_cbranch_scc1 LD_R3
    v_add_u32 v40, s30, v40
    s_lshl_b32 s30, s30, 4
    s_add_u32 s56, s58, s30
    s_add_u32 s57, s59, s30
    v_mul_hi_u32 v41, v40, s40
    v_mul_u32_u24 v42, s41, v41
    v_sub_u32 v42, v40, v42
    v_mul_u32_u24 v43, 37, v42
    v_lshrrev_b32 v43, 8, v43
    v_cmp_eq_u32 vcc, 21, v42
    v_bfe_u32 v45, v41, 2, 2
    v_bfe_u32 v46, v41, 4, 1
    v_and_b32 v41, 35, v41
    v_lshl_add_u32 v41, v45, 3, v41
    v_lshl_add_u32 v41, v46, 2, v41
    v_mul_u32_u24 v24, 2688, v41
    v_mul_u32_u24 v43, 784, v43
    v_add3_u32 v24, v24, v43, s42
    v_lshl_add_u32 v24, v42, 4, v24
    v_cndmask_b32 v24, v24, v47, vcc
    v_add_u32 v25, 86016, v24
LD_R3:
    s_mov_b32 m0, s56
    s_add_u32 s34, s34, 1
    buffer_load_dwordx4 v24, s[44:47], s37 offen lds
    s_mov_b32 m0, s57
    s_cmp_eq_u32 s34, 7
    buffer_load_dwordx4 v25, s[44:47], s37 offen lds
    s_cselect_b32 s34, 0, s34
    s_cmp_eq_u32 s24, 0
    s_cbranch_scc1 LD_A
    s_add_u32 s43, s43, 256
    v_add_u32 v40, s43, v5
    s_add_u32 s60, s58, 4096
    v_mul_hi_u32 v41, v40, s40
    v_mul_u32_u24 v42, s41, v41
    v_sub_u32 v42, v40, v42
    v_mul_u32_u24 v43, 37, v42
    v_lshrrev_b32 v43, 8, v43
    v_cmp_eq_u32 vcc, 21, v42
    v_bfe_u32 v45, v41, 2, 2
    v_bfe_u32 v46, v41, 4, 1
    v_and_b32 v41, 35, v41
    v_lshl_add_u32 v41, v45, 3, v41
    v_lshl_add_u32 v41, v46, 2, v41
    v_mul_u32_u24 v28, 2688, v41
    v_mul_u32_u24 v43, 784, v43
    v_add3_u32 v28, v28, v43, s42
    v_lshl_add_u32 v28, v42, 4, v28
    v_cndmask_b32 v28, v28, v47, vcc
    v_add_u32 v29, 86016, v28
    s_mov_b32 m0, s60
    s_add_u32 s61, s59, 4096
    buffer_load_dwordx4 v28, s[16:19], s36 offen lds
    s_mov_b32 m0, s61
    s_nop 0
    buffer_load_dwordx4 v29, s[16:19], s36 offen lds
    s_branch LD_B
LD_A:
    s_setprio 2
    s_lshl_b32 s60, s38, 10
    s_add_u32 s60, s60, 100352
    s_add_u32 s61, s60, 4096
    s_cmp_eq_u32 s38, 2
    s_cselect_b64 vcc, -1, 0
    s_cselect_b32 s55, 92160, s55
    v_cndmask_b32 v23, v23, v47, vcc
    s_cmp_eq_u32 s38, 3
    s_cselect_b32 s61, 158720, s61
    s_cselect_b32 s85, 0, 7168
    s_mov_b32 s20, s8
    s_and_b32 s21, s9, 0xffff
    s_mov_b32 s22, 33554432
    s_mov_b32 s23, 0x00020000
    s_andn2_b32 s90, s86, 15
    s_sub_u32 s29, s90, 512
    s_subb_u32 s30, s87, 0
    v_mov_b32 v240, s29
    v_mov_b32 v241, s30
    s_or_b32 s90, s90, s88
    s_xor_b32 s90, s90, 0x7f4a7c10
    s_xor_b32 s91, s87, 0x9e3779b9
    v_mov_b32 v242, s90
    v_mov_b32 v243, s91
    v_mov_b32 v48, 0
    v_mov_b32 v49, 85904
    s_add_u32 s30, s38, 0
    s_lshl_b32 s30, s30, 6
    v_add_u32 v40, s30, v5
    v_mul_u32_u24 v41, 4682, v40
    v_lshrrev_b32 v41, 16, v41
    v_mul_u32_u24 v42, 14, v41
    v_sub_u32 v42, v40, v42
    v_cmp_lt_u32 vcc, 6, v42
    v_bfe_u32 v45, v41, 2, 2
    v_bfe_u32 v46, v41, 4, 1
    v_and_b32 v41, 35, v41
    v_lshl_add_u32 v41, v45, 3, v41
    v_lshl_add_u32 v41, v46, 2, v41
    v_cndmask_b32 v43, v48, v49, vcc
    v_mul_u32_u24 v28, 2688, v41
    v_lshl_add_u32 v28, v42, 4, v28
    v_add3_u32 v28, v28, v43, s32
    v_add_u32 v29, 86016, v28
    s_add_u32 s30, s38, 4
    s_lshl_b32 s30, s30, 6
    v_add_u32 v40, s30, v5
    v_mul_u32_u24 v41, 4682, v40
    v_lshrrev_b32 v41, 16, v41
    v_mul_u32_u24 v42, 14, v41
    v_sub_u32 v42, v40, v42
    v_cmp_lt_u32 vcc, 6, v42
    v_bfe_u32 v45, v41, 2, 2
    v_bfe_u32 v46, v41, 4, 1
    v_and_b32 v41, 35, v41
    v_lshl_add_u32 v41, v45, 3, v41
    v_lshl_add_u32 v41, v46, 2, v41
    v_cndmask_b32 v43, v48, v49, vcc
    v_mul_u32_u24 v29, 2688, v41
    v_lshl_add_u32 v29, v42, 4, v29
    v_add3_u32 v29, v29, v43, s32
    v_add_u32 v30, 86016, v29
    s_cmp_eq_u32 s38, 3
    s_cselect_b64 vcc, -1, 0
    v_cndmask_b32 v29, v29, v47, vcc
    s_mov_b32 s40, 0
    s_lshl_b32 s41, s38, 1
    v_lshrrev_b32 v6, 1, v16
    v_xor_b32 v6, v6, v17
    v_lshlrev_b32 v7, 7, v16
    v_lshl_add_u32 v6, v6, 4, v7
    v_xor_b32 v7, 64, v6
    s_lshl_b32 s29, s41, 11
    v_add_u32 v2, s29, v6
    v_add_u32 v3, s29, v7
    v_lshrrev_b32 v4, 2, v16
    v_lshl_add_u32 v4, v17, 2, v4
    v_mul_u32_u24 v4, 224, v4
    v_and_b32 v8, 3, v16
    v_lshl_add_u32 v4, v8, 3, v4
    s_mul_i32 s29, s40, 56
    s_add_u32 s29, s29, 100352
    v_add_u32 v4, s29, v4
    s_lshl_b32 s31, s26, 1
    s_add_u32 s31, s31, s40
    s_lshl_b32 s29, s25, 3
    s_add_u32 s29, s29, s41
    s_lshl_b32 s29, s29, 4
    s_add_u32 s29, s29, s31
    s_lshl_b32 s70, s29, 10
    s_lshl_b32 s29, s25, 3
    s_add_u32 s29, s29, s26
    s_lshl_b32 s29, s29, 7
    s_lshl_b32 s30, s27, 3
    s_add_u32 s29, s29, s30
    s_add_u32 s29, s29, 6815744
    s_cmp_eq_u32 s96, 0
    s_cselect_b32 s29, s29, 0x7fff0000
    v_mov_b32 v9, 0x7fff0000
    v_writelane_b32 v9, s29, 0
    s_bfe_u32 s31, s2, 0x20001
    s_lshl_b32 s31, s31, 3
    s_add_u32 s31, s31, s26
    s_lshr_b32 s29, s31, 1
    s_lshl_b32 s29, s29, 3
    s_add_u32 s29, s29, s27
    s_lshl_b32 s29, s29, 7
    s_add_u32 s29, s29, 6815776
    v_and_b32 v10, 3, v5
    v_lshlrev_b32 v10, 3, v10
    v_add_u32 v10, s29, v10
    s_lshl_b32 s29, s27, 12
    v_add_u32 v12, s29, v13
    v_mov_b32 v224, v47
    v_mov_b32 v225, v47
    v_mov_b32 v226, v47
    v_mov_b32 v227, v47
    v_mov_b32 v228, v47
    v_mov_b32 v229, v47
    v_mov_b32 v230, v47
    s_lshl_b32 s29, s27, 11
    v_add_u32 v15, s29, v13
    s_lshl_b32 s72, s31, 16
    s_add_u32 s73, s72, 16384
    s_add_u32 s74, s72, 32768
    s_add_u32 s75, s72, 49152
    s_bfe_u32 s32, s2, 0x20003
    s_lshl_b32 s29, s31, 6
    v_add_u32 v14, s29, v16
    v_mul_u32_u24 v14, 1792, v14
    v_lshl_add_u32 v14, v17, 3, v14
    s_lshl_b32 s29, s27, 5
    s_mul_i32 s30, s32, 224
    s_add_u32 s29, s29, s30
    v_add_u32 v14, s29, v14
    s_mov_b32 s76, 0
    s_mov_b32 s77, 28672
    s_mov_b32 s78, 57344
    s_mov_b32 s79, 86016
    s_lshl_b32 s29, s27, 2
    s_add_u32 s29, s29, 162816
    v_mov_b32 v30, s29
    v_and_b32 v31, 7, v5
    v_lshlrev_b32 v31, 2, v31
    v_add_u32 v31, 162816, v31
    v_cmp_eq_u32 s[66:67], 3, v17
    s_mov_b32 s68, 0x3fb8aa3b
    s_mov_b32 s69, 0x3fb8aa3b
    v_mov_b32 v248, 0
    v_mov_b32 v249, 0
    v_mov_b32 v250, 0
    v_mov_b32 v251, 0x358637bd
    v_add_u32 v11, 100352, v13
    v_lshlrev_b32 v1, 1, v16
    v_and_b32 v1, 24, v1
    s_lshl_b32 s29, s27, 5
    v_lshl_add_u32 v18, v8, 3, s29
    v_mul_u32_u24 v8, 672, v17
    v_add_u32 v8, v8, v18
    v_mul_u32_u24 v19, 224, v17
    v_add_u32 v18, v19, v8
    s_movk_i32 s30, 224
    s_mov_b32 s29, 0x3020100
    v_bfe_u32 v232, s29, v1, 8
    v_mad_u32_u24 v232, v232, s30, v18
    v_add_u32 v235, 50176, v232
    s_mov_b32 s29, 0x2c121110
    v_bfe_u32 v233, s29, v1, 8
    v_mad_u32_u24 v233, v233, s30, v8
    v_add_u32 v236, 50176, v233
    s_mov_b32 s29, 0x66652e2d
    v_bfe_u32 v234, s29, v1, 8
    v_mad_u32_u24 v234, v234, s30, v8
    v_add_u32 v237, 50176, v234
    v_mov_b32 v1, 0
    v_mov_b32 v18, 127
    ds_write2_b32 v30, v1, v1 offset0:24 offset1:48
    ds_write2_b32 v30, v1, v1 offset0:32 offset1:40
    s_lshl_b32 s29, s38, 5
    s_lshr_b32 s30, s2, 3
    s_add_u32 s29, s29, s30
    s_min_u32 s29, s29, 111
    s_mul_i32 s30, s29, 10752
    s_add_u32 s90, s6, s30
    s_addc_u32 s91, s7, 0
    s_mul_i32 s30, s29, 3584
    s_add_u32 s82, s10, s30
    s_addc_u32 s83, s11, 0
    s_lshl_b32 s35, s34, 7
    s_mul_i32 s36, s34, 172032
    s_cmp_eq_u32 s38, 3
    s_cselect_b32 s37, s35, s36
    s_add_u32 s34, s34, 1
    s_cmp_eq_u32 s34, 7
    s_cselect_b32 s34, 0, s34
    s_add_u32 m0, s58, 30720
    s_nop 0
    buffer_load_dwordx4 v26, s[16:19], s36 offen lds
    s_add_u32 m0, s59, 30720
    s_nop 0
    buffer_load_dwordx4 v27, s[16:19], s36 offen lds
    s_add_u32 m0, s56, 30720
    s_nop 0
    buffer_load_dwordx4 v24, s[44:47], s37 offen lds
    s_add_u32 m0, s57, 30720
    s_nop 0
    buffer_load_dwordx4 v25, s[44:47], s37 offen lds
    s_waitcnt vmcnt(4) lgkmcnt(0)
    s_barrier
    ds_read_b128 v[112:115], v2 offset:0
    ds_read_b128 v[116:119], v2 offset:2048
    ds_read_b128 v[120:123], v3 offset:0
    ds_read_b128 v[124:127], v3 offset:2048
    s_add_u32 m0, s52, 30720
    s_nop 0
    buffer_load_dwordx4 v20, s[12:15], s35 offen lds
    s_add_u32 m0, s53, 30720
    s_nop 0
    buffer_load_dwordx4 v21, s[12:15], s35 offen lds
    s_add_u32 m0, s54, 30720
    s_nop 0
    buffer_load_dwordx4 v22, s[12:15], s35 offen lds
    s_add_u32 m0, s55, 30720
    s_nop 0
    buffer_load_dwordx4 v23, s[12:15], s35 offen lds
    s_lshl_b32 s35, s34, 7
    s_mul_i32 s36, s34, 172032
    s_cmp_eq_u32 s38, 3
    s_cselect_b32 s37, s35, s36
    s_add_u32 s34, s34, 1
    s_cmp_eq_u32 s34, 7
    s_cselect_b32 s34, 0, s34
    s_add_u32 m0, s58, 61440
    s_nop 0
    buffer_load_dwordx4 v26, s[16:19], s36 offen lds
    s_add_u32 m0, s59, 61440
    s_nop 0
    buffer_load_dwordx4 v27, s[16:19], s36 offen lds
    s_add_u32 m0, s56, 61440
    s_nop 0
    buffer_load_dwordx4 v24, s[44:47], s37 offen lds
    s_add_u32 m0, s57, 61440
    s_nop 0
    buffer_load_dwordx4 v25, s[44:47], s37 offen lds
    s_waitcnt lgkmcnt(0)
    s_waitcnt vmcnt(4)
    s_barrier
    ds_read_b128 v[128:131], v2 offset:30720
    ds_read_b128 v[132:135], v2 offset:32768
    ds_read_b128 v[136:139], v3 offset:30720
    ds_read_b128 v[140:143], v3 offset:32768
    s_add_u32 m0, s52, 61440
    s_nop 0
    buffer_load_dwordx4 v20, s[12:15], s35 offen lds
    s_add_u32 m0, s53, 61440
    s_nop 0
    buffer_load_dwordx4 v21, s[12:15], s35 offen lds
    s_add_u32 m0, s54, 61440
    s_nop 0
    buffer_load_dwordx4 v22, s[12:15], s35 offen lds
    s_add_u32 m0, s55, 61440
    s_nop 0
    buffer_load_dwordx4 v23, s[12:15], s35 offen lds
    s_lshl_b32 s35, s34, 7
    s_mul_i32 s36, s34, 172032
    s_cmp_eq_u32 s38, 3
    s_cselect_b32 s37, s35, s36
    s_add_u32 s34, s34, 1
    s_cmp_eq_u32 s34, 7
    s_cselect_b32 s34, 0, s34
    s_add_u32 m0, s58, 0
    s_nop 0
    buffer_load_dwordx4 v26, s[16:19], s36 offen lds
    s_add_u32 m0, s59, 0
    s_nop 0
    buffer_load_dwordx4 v27, s[16:19], s36 offen lds
    s_add_u32 m0, s56, 0
    s_nop 0
    buffer_load_dwordx4 v24, s[44:47], s37 offen lds
    s_add_u32 m0, s57, 0
    s_nop 0
    buffer_load_dwordx4 v25, s[44:47], s37 offen lds
    s_waitcnt lgkmcnt(0)
    s_waitcnt vmcnt(4)
    s_barrier
    ds_read_b128 v[144:147], v2 offset:61440
    ds_read_b128 v[148:151], v2 offset:63488
    ds_read_b128 v[152:155], v3 offset:61440
    ds_read_b128 v[156:159], v3 offset:63488
    s_add_u32 m0, s52, 0
    s_nop 0
    buffer_load_dwordx4 v20, s[12:15], s35 offen lds
    s_add_u32 m0, s53, 0
    s_nop 0
    buffer_load_dwordx4 v21, s[12:15], s35 offen lds
    s_add_u32 m0, s54, 0
    s_nop 0
    buffer_load_dwordx4 v22, s[12:15], s35 offen lds
    s_add_u32 m0, s55, 0
    s_nop 0
    buffer_load_dwordx4 v23, s[12:15], s35 offen lds
    s_lshl_b32 s35, s34, 7
    s_mul_i32 s36, s34, 172032
    s_cmp_eq_u32 s38, 3
    s_cselect_b32 s37, s35, s36
    s_add_u32 s34, s34, 1
    s_cmp_eq_u32 s34, 7
    s_cselect_b32 s34, 0, s34
    s_add_u32 m0, s58, 30720
    s_nop 0
    buffer_load_dwordx4 v26, s[16:19], s36 offen lds
    s_add_u32 m0, s59, 30720
    s_nop 0
    buffer_load_dwordx4 v27, s[16:19], s36 offen lds
    s_add_u32 m0, s56, 30720
    s_nop 0
    buffer_load_dwordx4 v24, s[44:47], s37 offen lds
    s_add_u32 m0, s57, 30720
    s_nop 0
    buffer_load_dwordx4 v25, s[44:47], s37 offen lds
    s_waitcnt lgkmcnt(0)
    s_waitcnt vmcnt(4)
    s_barrier
    ds_read_b128 v[160:163], v2 offset:0
    ds_read_b128 v[164:167], v2 offset:2048
    ds_read_b128 v[168:171], v3 offset:0
    ds_read_b128 v[172:175], v3 offset:2048
    s_add_u32 m0, s52, 30720
    s_nop 0
    buffer_load_dwordx4 v20, s[12:15], s35 offen lds
    s_add_u32 m0, s53, 30720
    s_nop 0
    buffer_load_dwordx4 v21, s[12:15], s35 offen lds
    s_add_u32 m0, s54, 30720
    s_nop 0
    buffer_load_dwordx4 v22, s[12:15], s35 offen lds
    s_add_u32 m0, s55, 30720
    s_nop 0
    buffer_load_dwordx4 v23, s[12:15], s35 offen lds
    s_lshl_b32 s35, s34, 7
    s_mul_i32 s36, s34, 172032
    s_cmp_eq_u32 s38, 3
    s_cselect_b32 s37, s35, s36
    s_add_u32 s34, s34, 1
    s_cmp_eq_u32 s34, 7
    s_cselect_b32 s34, 0, s34
    s_add_u32 m0, s58, 61440
    s_nop 0
    buffer_load_dwordx4 v26, s[16:19], s36 offen lds
    s_add_u32 m0, s59, 61440
    s_nop 0
    buffer_load_dwordx4 v27, s[16:19], s36 offen lds
    s_add_u32 m0, s56, 61440
    s_nop 0
    buffer_load_dwordx4 v24, s[44:47], s37 offen lds
    s_add_u32 m0, s57, 61440
    s_nop 0
    buffer_load_dwordx4 v25, s[44:47], s37 offen lds
    s_waitcnt lgkmcnt(0)
    s_waitcnt vmcnt(4)
    s_barrier
    ds_read_b128 v[176:179], v2 offset:30720
    ds_read_b128 v[180:183], v2 offset:32768
    ds_read_b128 v[184:187], v3 offset:30720
    ds_read_b128 v[188:191], v3 offset:32768
    s_add_u32 m0, s52, 61440
    s_nop 0
    buffer_load_dwordx4 v20, s[12:15], s35 offen lds
    s_add_u32 m0, s53, 61440
    s_nop 0
    buffer_load_dwordx4 v21, s[12:15], s35 offen lds
    s_add_u32 m0, s54, 61440
    s_nop 0
    buffer_load_dwordx4 v22, s[12:15], s35 offen lds
    s_add_u32 m0, s55, 61440
    s_nop 0
    buffer_load_dwordx4 v23, s[12:15], s35 offen lds
    s_lshl_b32 s35, s34, 7
    s_mul_i32 s36, s34, 172032
    s_cmp_eq_u32 s38, 3
    s_cselect_b32 s37, s35, s36
    s_add_u32 s34, s34, 1
    s_cmp_eq_u32 s34, 7
    s_cselect_b32 s34, 0, s34
    s_add_u32 m0, s58, 0
    s_nop 0
    buffer_load_dwordx4 v26, s[16:19], s36 offen lds
    s_add_u32 m0, s59, 0
    s_nop 0
    buffer_load_dwordx4 v27, s[16:19], s36 offen lds
    s_add_u32 m0, s56, 0
    s_nop 0
    buffer_load_dwordx4 v24, s[44:47], s37 offen lds
    s_add_u32 m0, s57, 0
    s_nop 0
    buffer_load_dwordx4 v25, s[44:47], s37 offen lds
    s_waitcnt lgkmcnt(0)
    s_waitcnt vmcnt(4)
    s_barrier
    ds_read_b128 v[192:195], v2 offset:61440
    ds_read_b128 v[196:199], v2 offset:63488
    ds_read_b128 v[200:203], v3 offset:61440
    ds_read_b128 v[204:207], v3 offset:63488
    s_add_u32 m0, s52, 0
    s_nop 0
    buffer_load_dwordx4 v20, s[12:15], s35 offen lds
    s_add_u32 m0, s53, 0
    s_nop 0
    buffer_load_dwordx4 v21, s[12:15], s35 offen lds
    s_add_u32 m0, s54, 0
    s_nop 0
    buffer_load_dwordx4 v22, s[12:15], s35 offen lds
    s_add_u32 m0, s55, 0
    s_nop 0
    buffer_load_dwordx4 v23, s[12:15], s35 offen lds
    s_mul_i32 s36, s34, 172032
    s_mov_b32 m0, s60
    s_add_u32 s60, s60, 7168
    buffer_load_dwordx4 v28, s[16:19], s36 offen lds
    s_mov_b32 m0, s61
    s_add_u32 s61, s61, s85
    buffer_load_dwordx4 v29, s[16:19], s36 offen lds
    s_add_u32 s34, s34, 1
    s_cmp_eq_u32 s34, 7
    s_cselect_b32 s34, 0, s34
    s_mul_i32 s36, s34, 172032
    s_mov_b32 m0, s60
    s_add_u32 s60, s60, 7168
    buffer_load_dwordx4 v28, s[16:19], s36 offen lds
    s_mov_b32 m0, s61
    s_add_u32 s61, s61, s85
    buffer_load_dwordx4 v29, s[16:19], s36 offen lds
    s_add_u32 s34, s34, 1
    s_cmp_eq_u32 s34, 7
    s_cselect_b32 s34, 0, s34
    s_waitcnt lgkmcnt(0)
    s_waitcnt vmcnt(4)
    s_barrier
    ds_read_b128 v[208:211], v2 offset:0
    ds_read_b128 v[212:215], v2 offset:2048
    ds_read_b128 v[216:219], v3 offset:0
    ds_read_b128 v[220:223], v3 offset:2048
    s_mul_i32 s36, s34, 172032
    s_mov_b32 m0, s60
    s_add_u32 s60, s60, 7168
    buffer_load_dwordx4 v28, s[16:19], s36 offen lds
    s_mov_b32 m0, s61
    s_add_u32 s61, s61, s85
    buffer_load_dwordx4 v29, s[16:19], s36 offen lds
    s_add_u32 s34, s34, 1
    s_cmp_eq_u32 s34, 7
    s_cselect_b32 s34, 0, s34
    s_mul_i32 s36, s34, 172032
    s_mov_b32 m0, s60
    s_add_u32 s60, s60, 7168
    buffer_load_dwordx4 v28, s[16:19], s36 offen lds
    s_mov_b32 m0, s61
    s_add_u32 s61, s61, s85
    buffer_load_dwordx4 v29, s[16:19], s36 offen lds
    s_add_u32 s34, s34, 1
    s_cmp_eq_u32 s34, 7
    s_cselect_b32 s34, 0, s34
    s_mul_i32 s36, s34, 172032
    s_mov_b32 m0, s60
    s_add_u32 s60, s60, 7168
    buffer_load_dwordx4 v28, s[16:19], s36 offen lds
    s_mov_b32 m0, s61
    s_add_u32 s61, s61, s85
    buffer_load_dwordx4 v29, s[16:19], s36 offen lds
    s_add_u32 s34, s34, 1
    s_cmp_eq_u32 s34, 7
    s_cselect_b32 s34, 0, s34
    s_mul_i32 s36, s34, 172032
    s_mov_b32 m0, s60
    s_add_u32 s60, s60, 7168
    buffer_load_dwordx4 v28, s[16:19], s36 offen lds
    s_mov_b32 m0, s61
    s_add_u32 s61, s61, s85
    buffer_load_dwordx4 v29, s[16:19], s36 offen lds
    s_add_u32 s34, s34, 1
    s_cmp_eq_u32 s34, 7
    s_cselect_b32 s34, 0, s34
    s_mul_i32 s36, s34, 172032
    s_mov_b32 m0, s60
    s_add_u32 s60, s60, 7168
    buffer_load_dwordx4 v28, s[16:19], s36 offen lds
    s_mov_b32 m0, s61
    s_add_u32 s61, s61, s85
    buffer_load_dwordx4 v29, s[16:19], s36 offen lds
    s_add_u32 s34, s34, 1
    s_cmp_eq_u32 s34, 7
    s_cselect_b32 s34, 0, s34
    s_waitcnt lgkmcnt(0)
    ds_write_b32 v30, v18 offset:96
    s_waitcnt vmcnt(10)
    v_mov_b32 v1, 1
    ds_write_b32 v30, v1 offset:128
QS0:
    ds_read_b32 v1, v31 offset:128
    s_waitcnt lgkmcnt(0)
    v_cmp_gt_u32 vcc, 1, v1
    s_nop 4
    s_cbranch_vccnz QS0
    ds_read_b64_tr_b16 v[32:33], v4 offset:0
    ds_read_b64_tr_b16 v[34:35], v4 offset:3584
    ds_read_b64_tr_b16 v[36:37], v4 offset:32
    ds_read_b64_tr_b16 v[38:39], v4 offset:3616
    ds_read_b64_tr_b16 v[40:41], v4 offset:56
    ds_read_b64_tr_b16 v[42:43], v4 offset:3640
    ds_read_b64_tr_b16 v[44:45], v4 offset:88
    ds_read_b64_tr_b16 v[46:47], v4 offset:3672
    ds_read_b64_tr_b16 v[48:49], v4 offset:112
    ds_read_b64_tr_b16 v[50:51], v4 offset:3696
    ds_read_b64_tr_b16 v[52:53], v4 offset:144
    ds_read_b64_tr_b16 v[54:55], v4 offset:3728
    ds_read_b64_tr_b16 v[56:57], v4 offset:168
    ds_read_b64_tr_b16 v[58:59], v4 offset:3752
    ds_read_b64_tr_b16 v[60:61], v4 offset:200
    ds_read_b64_tr_b16 v[62:63], v4 offset:3784
    s_waitcnt lgkmcnt(8)
    v_mfma_f32_16x16x32_bf16 v[64:67], v[32:35], v[112:115], 0
    ds_read_b64_tr_b16 v[96:97], v4 offset:7168
    v_mfma_f32_16x16x32_bf16 v[68:71], v[36:39], v[112:115], 0
    ds_read_b64_tr_b16 v[98:99], v4 offset:10752
    v_mfma_f32_16x16x32_bf16 v[72:75], v[40:43], v[112:115], 0
    ds_read_b64_tr_b16 v[100:101], v4 offset:7200
    v_mfma_f32_16x16x32_bf16 v[76:79], v[44:47], v[112:115], 0
    ds_read_b64_tr_b16 v[102:103], v4 offset:10784
    v_mfma_f32_16x16x32_bf16 v[80:83], v[32:35], v[116:119], 0
    ds_read_b64_tr_b16 v[104:105], v4 offset:7224
    v_mfma_f32_16x16x32_bf16 v[84:87], v[36:39], v[116:119], 0
    ds_read_b64_tr_b16 v[106:107], v4 offset:10808
    v_mfma_f32_16x16x32_bf16 v[88:91], v[40:43], v[116:119], 0
    ds_read_b64_tr_b16 v[108:109], v4 offset:7256
    v_mfma_f32_16x16x32_bf16 v[92:95], v[44:47], v[116:119], 0
    ds_read_b64_tr_b16 v[110:111], v4 offset:10840
    s_waitcnt lgkmcnt(8)
    v_mfma_f32_16x16x32_bf16 v[64:67], v[48:51], v[120:123], v[64:67]
    ds_read_b64_tr_b16 v[32:33], v4 offset:7280
    v_mfma_f32_16x16x32_bf16 v[68:71], v[52:55], v[120:123], v[68:71]
    ds_read_b64_tr_b16 v[34:35], v4 offset:10864
    v_mfma_f32_16x16x32_bf16 v[72:75], v[56:59], v[120:123], v[72:75]
    ds_read_b64_tr_b16 v[36:37], v4 offset:7312
    v_mfma_f32_16x16x32_bf16 v[76:79], v[60:63], v[120:123], v[76:79]
    ds_read_b64_tr_b16 v[38:39], v4 offset:10896
    v_mfma_f32_16x16x32_bf16 v[80:83], v[48:51], v[124:127], v[80:83]
    ds_read_b64_tr_b16 v[40:41], v4 offset:7336
    v_mfma_f32_16x16x32_bf16 v[84:87], v[52:55], v[124:127], v[84:87]
    ds_read_b64_tr_b16 v[42:43], v4 offset:10920
    v_mfma_f32_16x16x32_bf16 v[88:91], v[56:59], v[124:127], v[88:91]
    ds_read_b64_tr_b16 v[44:45], v4 offset:7368
    v_mfma_f32_16x16x32_bf16 v[92:95], v[60:63], v[124:127], v[92:95]
    ds_read_b64_tr_b16 v[46:47], v4 offset:10952
    s_waitcnt lgkmcnt(8)
    v_mfma_f32_16x16x32_bf16 v[64:67], v[96:99], v[128:131], v[64:67]
    v_mfma_f32_16x16x32_bf16 v[68:71], v[100:103], v[128:131], v[68:71]
    v_mfma_f32_16x16x32_bf16 v[72:75], v[104:107], v[128:131], v[72:75]
    v_mfma_f32_16x16x32_bf16 v[76:79], v[108:111], v[128:131], v[76:79]
    v_mfma_f32_16x16x32_bf16 v[80:83], v[96:99], v[132:135], v[80:83]
    v_mfma_f32_16x16x32_bf16 v[84:87], v[100:103], v[132:135], v[84:87]
    v_mfma_f32_16x16x32_bf16 v[88:91], v[104:107], v[132:135], v[88:91]
    v_mfma_f32_16x16x32_bf16 v[92:95], v[108:111], v[132:135], v[92:95]
    s_waitcnt vmcnt(6)
    v_mov_b32 v1, 2
    ds_write_b32 v30, v1 offset:128
QS1:
    ds_read_b32 v1, v31 offset:128
    s_waitcnt lgkmcnt(0)
    v_cmp_gt_u32 vcc, 2, v1
    s_nop 4
    s_cbranch_vccnz QS1
    ds_read_b64_tr_b16 v[48:49], v4 offset:14336
    ds_read_b64_tr_b16 v[50:51], v4 offset:17920
    ds_read_b64_tr_b16 v[52:53], v4 offset:14368
    ds_read_b64_tr_b16 v[54:55], v4 offset:17952
    ds_read_b64_tr_b16 v[56:57], v4 offset:14392
    ds_read_b64_tr_b16 v[58:59], v4 offset:17976
    ds_read_b64_tr_b16 v[60:61], v4 offset:14424
    ds_read_b64_tr_b16 v[62:63], v4 offset:18008
    v_mfma_f32_16x16x32_bf16 v[64:67], v[32:35], v[136:139], v[64:67]
    ds_read_b64_tr_b16 v[96:97], v4 offset:14448
    v_mfma_f32_16x16x32_bf16 v[68:71], v[36:39], v[136:139], v[68:71]
    ds_read_b64_tr_b16 v[98:99], v4 offset:18032
    v_mfma_f32_16x16x32_bf16 v[72:75], v[40:43], v[136:139], v[72:75]
    ds_read_b64_tr_b16 v[100:101], v4 offset:14480
    v_mfma_f32_16x16x32_bf16 v[76:79], v[44:47], v[136:139], v[76:79]
    ds_read_b64_tr_b16 v[102:103], v4 offset:18064
    v_mfma_f32_16x16x32_bf16 v[80:83], v[32:35], v[140:143], v[80:83]
    ds_read_b64_tr_b16 v[104:105], v4 offset:14504
    v_mfma_f32_16x16x32_bf16 v[84:87], v[36:39], v[140:143], v[84:87]
    ds_read_b64_tr_b16 v[106:107], v4 offset:18088
    v_mfma_f32_16x16x32_bf16 v[88:91], v[40:43], v[140:143], v[88:91]
    ds_read_b64_tr_b16 v[108:109], v4 offset:14536
    v_mfma_f32_16x16x32_bf16 v[92:95], v[44:47], v[140:143], v[92:95]
    ds_read_b64_tr_b16 v[110:111], v4 offset:18120
    s_waitcnt lgkmcnt(8)
    v_mfma_f32_16x16x32_bf16 v[64:67], v[48:51], v[144:147], v[64:67]
    ds_read_b64_tr_b16 v[32:33], v4 offset:21504
    v_mfma_f32_16x16x32_bf16 v[68:71], v[52:55], v[144:147], v[68:71]
    ds_read_b64_tr_b16 v[34:35], v4 offset:25088
    v_mfma_f32_16x16x32_bf16 v[72:75], v[56:59], v[144:147], v[72:75]
    ds_read_b64_tr_b16 v[36:37], v4 offset:21536
    v_mfma_f32_16x16x32_bf16 v[76:79], v[60:63], v[144:147], v[76:79]
    ds_read_b64_tr_b16 v[38:39], v4 offset:25120
    v_mfma_f32_16x16x32_bf16 v[80:83], v[48:51], v[148:151], v[80:83]
    ds_read_b64_tr_b16 v[40:41], v4 offset:21560
    v_mfma_f32_16x16x32_bf16 v[84:87], v[52:55], v[148:151], v[84:87]
    ds_read_b64_tr_b16 v[42:43], v4 offset:25144
    v_mfma_f32_16x16x32_bf16 v[88:91], v[56:59], v[148:151], v[88:91]
    ds_read_b64_tr_b16 v[44:45], v4 offset:21592
    v_mfma_f32_16x16x32_bf16 v[92:95], v[60:63], v[148:151], v[92:95]
    ds_read_b64_tr_b16 v[46:47], v4 offset:25176
    s_waitcnt lgkmcnt(8)
    v_mfma_f32_16x16x32_bf16 v[64:67], v[96:99], v[152:155], v[64:67]
    ds_read_b64_tr_b16 v[48:49], v4 offset:21616
    v_mfma_f32_16x16x32_bf16 v[68:71], v[100:103], v[152:155], v[68:71]
    ds_read_b64_tr_b16 v[50:51], v4 offset:25200
    v_mfma_f32_16x16x32_bf16 v[72:75], v[104:107], v[152:155], v[72:75]
    ds_read_b64_tr_b16 v[52:53], v4 offset:21648
    v_mfma_f32_16x16x32_bf16 v[76:79], v[108:111], v[152:155], v[76:79]
    ds_read_b64_tr_b16 v[54:55], v4 offset:25232
    v_mfma_f32_16x16x32_bf16 v[80:83], v[96:99], v[156:159], v[80:83]
    ds_read_b64_tr_b16 v[56:57], v4 offset:21672
    v_mfma_f32_16x16x32_bf16 v[84:87], v[100:103], v[156:159], v[84:87]
    ds_read_b64_tr_b16 v[58:59], v4 offset:25256
    v_mfma_f32_16x16x32_bf16 v[88:91], v[104:107], v[156:159], v[88:91]
    ds_read_b64_tr_b16 v[60:61], v4 offset:21704
    v_mfma_f32_16x16x32_bf16 v[92:95], v[108:111], v[156:159], v[92:95]
    ds_read_b64_tr_b16 v[62:63], v4 offset:25288
    s_waitcnt lgkmcnt(8)
    v_mfma_f32_16x16x32_bf16 v[64:67], v[32:35], v[160:163], v[64:67]
    v_mfma_f32_16x16x32_bf16 v[68:71], v[36:39], v[160:163], v[68:71]
    v_mfma_f32_16x16x32_bf16 v[72:75], v[40:43], v[160:163], v[72:75]
    v_mfma_f32_16x16x32_bf16 v[76:79], v[44:47], v[160:163], v[76:79]
    v_mfma_f32_16x16x32_bf16 v[80:83], v[32:35], v[164:167], v[80:83]
    v_mfma_f32_16x16x32_bf16 v[84:87], v[36:39], v[164:167], v[84:87]
    v_mfma_f32_16x16x32_bf16 v[88:91], v[40:43], v[164:167], v[88:91]
    v_mfma_f32_16x16x32_bf16 v[92:95], v[44:47], v[164:167], v[92:95]
    s_waitcnt vmcnt(2)
    v_mov_b32 v1, 3
    ds_write_b32 v30, v1 offset:128
QS2:
    ds_read_b32 v1, v31 offset:128
    s_waitcnt lgkmcnt(0)
    v_cmp_gt_u32 vcc, 3, v1
    s_nop 4
    s_cbranch_vccnz QS2
    ds_read_b64_tr_b16 v[96:97], v4 offset:28672
    ds_read_b64_tr_b16 v[98:99], v4 offset:32256
    ds_read_b64_tr_b16 v[100:101], v4 offset:28704
    ds_read_b64_tr_b16 v[102:103], v4 offset:32288
    ds_read_b64_tr_b16 v[104:105], v4 offset:28728
    ds_read_b64_tr_b16 v[106:107], v4 offset:32312
    ds_read_b64_tr_b16 v[108:109], v4 offset:28760
    ds_read_b64_tr_b16 v[110:111], v4 offset:32344
    v_mfma_f32_16x16x32_bf16 v[64:67], v[48:51], v[168:171], v[64:67]
    ds_read_b64_tr_b16 v[32:33], v4 offset:28784
    v_mfma_f32_16x16x32_bf16 v[68:71], v[52:55], v[168:171], v[68:71]
    ds_read_b64_tr_b16 v[34:35], v4 offset:32368
    v_mfma_f32_16x16x32_bf16 v[72:75], v[56:59], v[168:171], v[72:75]
    ds_read_b64_tr_b16 v[36:37], v4 offset:28816
    v_mfma_f32_16x16x32_bf16 v[76:79], v[60:63], v[168:171], v[76:79]
    ds_read_b64_tr_b16 v[38:39], v4 offset:32400
    v_mfma_f32_16x16x32_bf16 v[80:83], v[48:51], v[172:175], v[80:83]
    ds_read_b64_tr_b16 v[40:41], v4 offset:28840
    v_mfma_f32_16x16x32_bf16 v[84:87], v[52:55], v[172:175], v[84:87]
    ds_read_b64_tr_b16 v[42:43], v4 offset:32424
    v_mfma_f32_16x16x32_bf16 v[88:91], v[56:59], v[172:175], v[88:91]
    ds_read_b64_tr_b16 v[44:45], v4 offset:28872
    v_mfma_f32_16x16x32_bf16 v[92:95], v[60:63], v[172:175], v[92:95]
    ds_read_b64_tr_b16 v[46:47], v4 offset:32456
    s_waitcnt lgkmcnt(8)
    v_mfma_f32_16x16x32_bf16 v[64:67], v[96:99], v[176:179], v[64:67]
    ds_read_b64_tr_b16 v[48:49], v4 offset:35840
    v_mfma_f32_16x16x32_bf16 v[68:71], v[100:103], v[176:179], v[68:71]
    ds_read_b64_tr_b16 v[50:51], v4 offset:39424
    v_mfma_f32_16x16x32_bf16 v[72:75], v[104:107], v[176:179], v[72:75]
    ds_read_b64_tr_b16 v[52:53], v4 offset:35872
    v_mfma_f32_16x16x32_bf16 v[76:79], v[108:111], v[176:179], v[76:79]
    ds_read_b64_tr_b16 v[54:55], v4 offset:39456
    v_mfma_f32_16x16x32_bf16 v[80:83], v[96:99], v[180:183], v[80:83]
    ds_read_b64_tr_b16 v[56:57], v4 offset:35896
    v_mfma_f32_16x16x32_bf16 v[84:87], v[100:103], v[180:183], v[84:87]
    ds_read_b64_tr_b16 v[58:59], v4 offset:39480
    v_mfma_f32_16x16x32_bf16 v[88:91], v[104:107], v[180:183], v[88:91]
    ds_read_b64_tr_b16 v[60:61], v4 offset:35928
    v_mfma_f32_16x16x32_bf16 v[92:95], v[108:111], v[180:183], v[92:95]
    ds_read_b64_tr_b16 v[62:63], v4 offset:39512
    s_waitcnt lgkmcnt(8)
    v_mfma_f32_16x16x32_bf16 v[64:67], v[32:35], v[184:187], v[64:67]
    ds_read_b64_tr_b16 v[96:97], v4 offset:35952
    v_mfma_f32_16x16x32_bf16 v[68:71], v[36:39], v[184:187], v[68:71]
    ds_read_b64_tr_b16 v[98:99], v4 offset:39536
    v_mfma_f32_16x16x32_bf16 v[72:75], v[40:43], v[184:187], v[72:75]
    ds_read_b64_tr_b16 v[100:101], v4 offset:35984
    v_mfma_f32_16x16x32_bf16 v[76:79], v[44:47], v[184:187], v[76:79]
    ds_read_b64_tr_b16 v[102:103], v4 offset:39568
    v_mfma_f32_16x16x32_bf16 v[80:83], v[32:35], v[188:191], v[80:83]
    ds_read_b64_tr_b16 v[104:105], v4 offset:36008
    v_mfma_f32_16x16x32_bf16 v[84:87], v[36:39], v[188:191], v[84:87]
    ds_read_b64_tr_b16 v[106:107], v4 offset:39592
    v_mfma_f32_16x16x32_bf16 v[88:91], v[40:43], v[188:191], v[88:91]
    ds_read_b64_tr_b16 v[108:109], v4 offset:36040
    v_mfma_f32_16x16x32_bf16 v[92:95], v[44:47], v[188:191], v[92:95]
    ds_read_b64_tr_b16 v[110:111], v4 offset:39624
    s_waitcnt lgkmcnt(8)
    v_mfma_f32_16x16x32_bf16 v[64:67], v[48:51], v[192:195], v[64:67]
    v_mfma_f32_16x16x32_bf16 v[68:71], v[52:55], v[192:195], v[68:71]
    v_mfma_f32_16x16x32_bf16 v[72:75], v[56:59], v[192:195], v[72:75]
    v_mfma_f32_16x16x32_bf16 v[76:79], v[60:63], v[192:195], v[76:79]
    v_mfma_f32_16x16x32_bf16 v[80:83], v[48:51], v[196:199], v[80:83]
    v_mfma_f32_16x16x32_bf16 v[84:87], v[52:55], v[196:199], v[84:87]
    v_mfma_f32_16x16x32_bf16 v[88:91], v[56:59], v[196:199], v[88:91]
    v_mfma_f32_16x16x32_bf16 v[92:95], v[60:63], v[196:199], v[92:95]
    s_waitcnt vmcnt(0)
    v_mov_b32 v1, 4
    ds_write_b32 v30, v1 offset:128
QS3:
    ds_read_b32 v1, v31 offset:128
    s_waitcnt lgkmcnt(0)
    v_cmp_gt_u32 vcc, 4, v1
    s_nop 4
    s_cbranch_vccnz QS3
    ds_read_b64_tr_b16 v[32:33], v4 offset:43008
    ds_read_b64_tr_b16 v[34:35], v4 offset:46592
    ds_read_b64_tr_b16 v[36:37], v4 offset:43040
    ds_read_b64_tr_b16 v[38:39], v4 offset:46624
    ds_read_b64_tr_b16 v[40:41], v4 offset:43064
    ds_read_b64_tr_b16 v[42:43], v4 offset:46648
    ds_read_b64_tr_b16 v[44:45], v4 offset:43096
    ds_read_b64_tr_b16 v[46:47], v4 offset:46680
    v_mfma_f32_16x16x32_bf16 v[64:67], v[96:99], v[200:203], v[64:67]
    ds_read_b64_tr_b16 v[48:49], v4 offset:43120
    ds_read_b64_tr_b16 v[50:51], v4 offset:46704
    v_mfma_f32_16x16x32_bf16 v[68:71], v[100:103], v[200:203], v[68:71]
    ds_read_b64_tr_b16 v[52:53], v4 offset:43152
    ds_read_b64_tr_b16 v[54:55], v4 offset:46736
    v_mfma_f32_16x16x32_bf16 v[72:75], v[104:107], v[200:203], v[72:75]
    ds_read_b64_tr_b16 v[56:57], v4 offset:43176
    ds_read_b64_tr_b16 v[58:59], v4 offset:46760
    v_mfma_f32_16x16x32_bf16 v[76:79], v[108:111], v[200:203], v[76:79]
    ds_read_b64_tr_b16 v[60:61], v4 offset:43208
    ds_read_b64_tr_b16 v[62:63], v4 offset:46792
    s_waitcnt lgkmcnt(8)
    v_mfma_f32_16x16x32_bf16 v[64:67], v[32:35], v[208:211], v[64:67]
    v_mfma_f32_16x16x32_bf16 v[68:71], v[36:39], v[208:211], v[68:71]
    v_mfma_f32_16x16x32_bf16 v[72:75], v[40:43], v[208:211], v[72:75]
    v_mfma_f32_16x16x32_bf16 v[76:79], v[44:47], v[208:211], v[76:79]
    s_waitcnt lgkmcnt(0)
    v_mfma_f32_16x16x32_bf16 v[64:67], v[48:51], v[216:219], v[64:67]
    v_mfma_f32_16x16x32_bf16 v[68:71], v[52:55], v[216:219], v[68:71]
    v_mfma_f32_16x16x32_bf16 v[72:75], v[56:59], v[216:219], v[72:75]
    v_mfma_f32_16x16x32_bf16 v[76:79], v[60:63], v[216:219], v[76:79]
    ds_write_b32 v30, v18 offset:160
    v_mov_b32 v1, 162880
    ds_read_b32 v22, v1
    v_mfma_f32_16x16x32_bf16 v[80:83], v[96:99], v[204:207], v[80:83]
    v_mfma_f32_16x16x32_bf16 v[84:87], v[100:103], v[204:207], v[84:87]
    v_mfma_f32_16x16x32_bf16 v[88:91], v[104:107], v[204:207], v[88:91]
    v_mfma_f32_16x16x32_bf16 v[92:95], v[108:111], v[204:207], v[92:95]
    v_pk_mul_f32 v[112:113], v[64:65], s[68:69]
    v_pk_mul_f32 v[114:115], v[66:67], s[68:69]
    v_pk_mul_f32 v[116:117], v[68:69], s[68:69]
    v_mfma_f32_16x16x32_bf16 v[80:83], v[32:35], v[212:215], v[80:83]
    v_pk_mul_f32 v[118:119], v[70:71], s[68:69]
    v_pk_mul_f32 v[120:121], v[72:73], s[68:69]
    v_pk_mul_f32 v[122:123], v[74:75], s[68:69]
    v_mfma_f32_16x16x32_bf16 v[84:87], v[36:39], v[212:215], v[84:87]
    v_pk_mul_f32 v[124:125], v[76:77], s[68:69]
    v_pk_mul_f32 v[126:127], v[78:79], s[68:69]
    v_exp_f32 v112, v112 clamp
    v_mfma_f32_16x16x32_bf16 v[88:91], v[40:43], v[212:215], v[88:91]
    v_exp_f32 v113, v113 clamp
    v_exp_f32 v114, v114 clamp
    v_exp_f32 v115, v115 clamp
    v_mfma_f32_16x16x32_bf16 v[92:95], v[44:47], v[212:215], v[92:95]
    v_exp_f32 v116, v116 clamp
    v_exp_f32 v117, v117 clamp
    v_exp_f32 v118, v118 clamp
    v_mfma_f32_16x16x32_bf16 v[80:83], v[48:51], v[220:223], v[80:83]
    v_exp_f32 v119, v119 clamp
    v_exp_f32 v120, v120 clamp
    v_exp_f32 v121, v121 clamp
    v_mfma_f32_16x16x32_bf16 v[84:87], v[52:55], v[220:223], v[84:87]
    v_exp_f32 v122, v122 clamp
    v_exp_f32 v123, v123 clamp
    v_exp_f32 v124, v124 clamp
    v_mfma_f32_16x16x32_bf16 v[88:91], v[56:59], v[220:223], v[88:91]
    v_exp_f32 v125, v125 clamp
    v_exp_f32 v126, v126 clamp
    v_exp_f32 v127, v127 clamp
    v_mfma_f32_16x16x32_bf16 v[92:95], v[60:63], v[220:223], v[92:95]
    v_max_f32 v64, 0x358637bd, v64
    v_max_f32 v65, 0x358637bd, v65
    v_max_f32 v66, 0x358637bd, v66
    v_max_f32 v67, 0x358637bd, v67
    v_max_f32 v68, 0x358637bd, v68
    v_max_f32 v69, 0x358637bd, v69
    v_max_f32 v70, 0x358637bd, v70
    v_max_f32 v71, 0x358637bd, v71
    v_max_f32 v72, 0x358637bd, v72
    v_max_f32 v73, 0x358637bd, v73
    v_max_f32 v74, 0x358637bd, v74
    v_max_f32 v75, 0x358637bd, v75
    v_max_f32 v76, 0x358637bd, v76
    v_max_f32 v77, 0x358637bd, v77
    v_max_f32 v78, 0x358637bd, v78
    v_max_f32 v79, 0x358637bd, v79
    v_pk_add_f32 v[112:113], v[112:113], v[64:65]
    v_pk_add_f32 v[114:115], v[114:115], v[66:67]
    v_pk_add_f32 v[116:117], v[116:117], v[68:69]
    v_pk_add_f32 v[118:119], v[118:119], v[70:71]
    v_pk_add_f32 v[120:121], v[120:121], v[72:73]
    v_pk_add_f32 v[122:123], v[122:123], v[74:75]
    v_pk_add_f32 v[124:125], v[124:125], v[76:77]
    v_pk_add_f32 v[126:127], v[126:127], v[78:79]
    v_cvt_pk_bf16_f32 v128, v112, v113
    v_cvt_pk_bf16_f32 v129, v114, v115
    v_cvt_pk_bf16_f32 v130, v116, v117
    v_cvt_pk_bf16_f32 v131, v118, v119
    v_cvt_pk_bf16_f32 v132, v120, v121
    v_cvt_pk_bf16_f32 v133, v122, v123
    v_cvt_pk_bf16_f32 v134, v124, v125
    v_cvt_pk_bf16_f32 v135, v126, v127
QP_W:
    s_waitcnt lgkmcnt(0)
    v_readfirstlane_b32 s92, v22
    ds_read_b32 v22, v1
    s_cmp_gt_u32 s92, 1
    s_cbranch_scc1 QP_W
    v_cndmask_b32 v130, v130, 0, s[66:67]
    v_cndmask_b32 v131, v131, 0, s[66:67]
    v_cndmask_b32 v134, v134, 0, s[66:67]
    v_cndmask_b32 v135, v135, 0, s[66:67]
    buffer_store_dwordx4 v[128:131], v13, s[20:23], s70 offen offset:0 sc0 sc1
    buffer_store_dwordx4 v[132:135], v13, s[20:23], s70 offen offset:1024 sc0 sc1
    s_add_u32 s70, s70, 16384
    v_pk_mul_f32 v[112:113], v[80:81], s[68:69]
    v_pk_mul_f32 v[114:115], v[82:83], s[68:69]
    v_pk_mul_f32 v[116:117], v[84:85], s[68:69]
    v_pk_mul_f32 v[118:119], v[86:87], s[68:69]
    v_pk_mul_f32 v[120:121], v[88:89], s[68:69]
    v_pk_mul_f32 v[122:123], v[90:91], s[68:69]
    v_pk_mul_f32 v[124:125], v[92:93], s[68:69]
    v_pk_mul_f32 v[126:127], v[94:95], s[68:69]
    v_exp_f32 v112, v112 clamp
    v_exp_f32 v113, v113 clamp
    v_exp_f32 v114, v114 clamp
    v_exp_f32 v115, v115 clamp
    v_exp_f32 v116, v116 clamp
    v_exp_f32 v117, v117 clamp
    v_exp_f32 v118, v118 clamp
    v_exp_f32 v119, v119 clamp
    v_exp_f32 v120, v120 clamp
    v_exp_f32 v121, v121 clamp
    v_exp_f32 v122, v122 clamp
    v_exp_f32 v123, v123 clamp
    v_exp_f32 v124, v124 clamp
    v_exp_f32 v125, v125 clamp
    v_exp_f32 v126, v126 clamp
    v_exp_f32 v127, v127 clamp
    v_max_f32 v80, 0x358637bd, v80
    v_max_f32 v81, 0x358637bd, v81
    v_max_f32 v82, 0x358637bd, v82
    v_max_f32 v83, 0x358637bd, v83
    v_max_f32 v84, 0x358637bd, v84
    v_max_f32 v85, 0x358637bd, v85
    v_max_f32 v86, 0x358637bd, v86
    v_max_f32 v87, 0x358637bd, v87
    v_max_f32 v88, 0x358637bd, v88
    v_max_f32 v89, 0x358637bd, v89
    v_max_f32 v90, 0x358637bd, v90
    v_max_f32 v91, 0x358637bd, v91
    v_max_f32 v92, 0x358637bd, v92
    v_max_f32 v93, 0x358637bd, v93
    v_max_f32 v94, 0x358637bd, v94
    v_max_f32 v95, 0x358637bd, v95
    v_pk_add_f32 v[112:113], v[112:113], v[80:81]
    v_pk_add_f32 v[114:115], v[114:115], v[82:83]
    v_pk_add_f32 v[116:117], v[116:117], v[84:85]
    v_pk_add_f32 v[118:119], v[118:119], v[86:87]
    v_pk_add_f32 v[120:121], v[120:121], v[88:89]
    v_pk_add_f32 v[122:123], v[122:123], v[90:91]
    v_pk_add_f32 v[124:125], v[124:125], v[92:93]
    v_pk_add_f32 v[126:127], v[126:127], v[94:95]
    v_cvt_pk_bf16_f32 v136, v112, v113
    v_cvt_pk_bf16_f32 v137, v114, v115
    v_cvt_pk_bf16_f32 v138, v116, v117
    v_cvt_pk_bf16_f32 v139, v118, v119
    v_cvt_pk_bf16_f32 v140, v120, v121
    v_cvt_pk_bf16_f32 v141, v122, v123
    v_cvt_pk_bf16_f32 v142, v124, v125
    v_cvt_pk_bf16_f32 v143, v126, v127
    v_cndmask_b32 v138, v138, 0, s[66:67]
    v_cndmask_b32 v139, v139, 0, s[66:67]
    v_cndmask_b32 v142, v142, 0, s[66:67]
    v_cndmask_b32 v143, v143, 0, s[66:67]
    buffer_store_dwordx4 v[136:139], v13, s[20:23], s70 offen offset:0 sc0 sc1
    buffer_store_dwordx4 v[140:143], v13, s[20:23], s70 offen offset:1024 sc0 sc1
    s_branch P2
LD_B:
    s_setprio 2
    v_lshrrev_b32 v6, 3, v5
    v_and_b32 v7, 7, v5
    v_mul_u32_u24 v199, 896, v6
    v_lshl_add_u32 v199, v7, 4, v199
    s_mov_b32 s48, s10
    s_and_b32 s49, s11, 0xffff
    s_mov_b32 s50, 401408
    s_mov_b32 s51, 0x00020000
    s_mov_b32 s20, s8
    s_and_b32 s21, s9, 0xffff
    s_mov_b32 s22, 33554432
    s_mov_b32 s23, 0x00020000
    s_andn2_b32 s90, s86, 15
    s_sub_u32 s29, s90, 512
    s_subb_u32 s30, s87, 0
    v_mov_b32 v240, s29
    v_mov_b32 v241, s30
    s_or_b32 s90, s90, s88
    s_xor_b32 s90, s90, 0x7f4a7c10
    s_xor_b32 s91, s87, 0x9e3779b9
    v_mov_b32 v242, s90
    v_mov_b32 v243, s91
    s_and_b32 s29, s27, 1
    s_bfe_u32 s40, s27, 0x10001
    s_lshl_b32 s41, s29, 1
    s_add_u32 s41, s41, 4
    v_lshrrev_b32 v6, 1, v16
    v_xor_b32 v6, v6, v17
    v_lshlrev_b32 v7, 7, v16
    v_lshl_add_u32 v6, v6, 4, v7
    v_xor_b32 v7, 64, v6
    s_lshl_b32 s29, s41, 11
    s_add_u32 s29, s29, 2048
    v_add_u32 v2, s29, v6
    v_add_u32 v3, s29, v7
    v_lshrrev_b32 v4, 2, v16
    v_lshl_add_u32 v4, v17, 2, v4
    v_mul_u32_u24 v4, 352, v4
    v_and_b32 v8, 3, v16
    v_lshl_add_u32 v4, v8, 3, v4
    s_mul_i32 s29, s40, 56
    s_add_u32 s29, s29, 18432
    v_add_u32 v4, s29, v4
    s_mov_b32 s42, 0
    s_mov_b32 s39, 0
    s_lshl_b32 s31, s26, 1
    s_add_u32 s31, s31, s40
    s_lshl_b32 s29, s25, 3
    s_add_u32 s29, s29, s41
    s_lshl_b32 s29, s29, 4
    s_add_u32 s29, s29, s31
    s_lshl_b32 s70, s29, 10
    s_add_u32 s70, s70, 2097152
    s_lshl_b32 s29, s25, 3
    s_add_u32 s29, s29, s26
    s_lshl_b32 s29, s29, 7
    s_lshl_b32 s30, s27, 3
    s_add_u32 s29, s29, s30
    s_add_u32 s29, s29, 6832128
    s_cmp_eq_u32 s96, 0
    s_cselect_b32 s29, s29, 0x7fff0000
    v_mov_b32 v9, 0x7fff0000
    v_writelane_b32 v9, s29, 0
    s_bfe_u32 s31, s2, 0x20001
    s_lshl_b32 s31, s31, 3
    s_add_u32 s31, s31, s26
    s_lshr_b32 s29, s31, 1
    s_lshl_b32 s29, s29, 3
    s_add_u32 s29, s29, s27
    s_lshl_b32 s29, s29, 7
    s_and_b32 s30, s31, 1
    s_lshl_b32 s30, s30, 5
    s_add_u32 s29, s29, s30
    s_add_u32 s29, s29, 6832128
    v_and_b32 v10, 3, v5
    v_lshlrev_b32 v10, 3, v10
    v_add_u32 v10, s29, v10
    s_lshl_b32 s29, s27, 12
    v_add_u32 v12, s29, v13
    s_lshl_b32 s29, s27, 11
    v_add_u32 v15, s29, v13
    s_lshl_b32 s72, s31, 16
    s_add_u32 s72, s72, 2097152
    s_add_u32 s73, s72, 16384
    s_add_u32 s74, s72, 32768
    s_add_u32 s75, s72, 49152
    s_bfe_u32 s32, s2, 0x20003
    s_lshl_b32 s29, s31, 6
    v_add_u32 v14, s29, v16
    v_mul_u32_u24 v14, 1792, v14
    v_lshl_add_u32 v14, v17, 3, v14
    s_lshl_b32 s29, s27, 5
    s_mul_i32 s30, s32, 224
    s_add_u32 s29, s29, s30
    s_add_u32 s29, s29, 896
    v_add_u32 v14, s29, v14
    s_mov_b32 s76, 0
    s_mov_b32 s77, 28672
    s_mov_b32 s78, 57344
    s_mov_b32 s79, 86016
    s_lshl_b32 s29, s27, 2
    s_add_u32 s29, s29, 162816
    v_mov_b32 v30, s29
    v_and_b32 v31, 7, v5
    v_lshlrev_b32 v31, 2, v31
    v_add_u32 v31, 162816, v31
    v_cmp_eq_u32 s[66:67], 3, v17
    s_mul_i32 s29, s32, 7
    s_add_u32 s29, s29, s27
    s_lshl_b32 s29, s29, 14
    s_cmp_eq_u32 s27, 7
    s_cselect_b32 s29, 0x7fff0000, s29
    v_add_u32 v18, s29, v13
    s_and_b32 s29, s2, 7
    s_lshl_b32 s29, s29, 19
    s_add_u32 s71, s29, 9437184
    s_add_u32 s82, s71, 4096
    s_add_u32 s83, s71, 8192
    s_add_u32 s84, s71, 12288
    v_lshlrev_b32 v8, 2, v17
    v_sub_u32 v8, v16, v8
    v_add_u32 v8, 16, v8
    v_mov_b32 v1, 0xcfb2d05e
    v_subrev_u32 v168, 0, v8
    v_alignbit_b32 v168, v168, v168, 1
    v_subrev_u32 v169, 1, v8
    v_alignbit_b32 v169, v169, v169, 1
    v_subrev_u32 v170, 2, v8
    v_alignbit_b32 v170, v170, v170, 1
    v_subrev_u32 v171, 3, v8
    v_alignbit_b32 v171, v171, v171, 1
    v_subrev_u32 v172, 16, v8
    v_alignbit_b32 v172, v172, v172, 1
    v_subrev_u32 v173, 17, v8
    v_alignbit_b32 v173, v173, v173, 1
    v_subrev_u32 v174, 18, v8
    v_alignbit_b32 v174, v174, v174, 1
    v_subrev_u32 v175, 19, v8
    v_alignbit_b32 v175, v175, v175, 1
    v_cmp_ge_u32 vcc, 7, v168
    s_nop 1
    v_cndmask_b32 v168, v1, 0, vcc
    v_cmp_ge_u32 vcc, 7, v169
    s_nop 1
    v_cndmask_b32 v169, v1, 0, vcc
    v_cmp_ge_u32 vcc, 7, v170
    s_nop 1
    v_cndmask_b32 v170, v1, 0, vcc
    v_cmp_ge_u32 vcc, 7, v171
    s_nop 1
    v_cndmask_b32 v171, v1, 0, vcc
    v_cmp_ge_u32 vcc, 7, v172
    s_nop 1
    v_cndmask_b32 v172, v1, 0, vcc
    v_cmp_ge_u32 vcc, 7, v173
    s_nop 1
    v_cndmask_b32 v173, v1, 0, vcc
    v_cmp_ge_u32 vcc, 7, v174
    s_nop 1
    v_cndmask_b32 v174, v1, 0, vcc
    v_cmp_ge_u32 vcc, 7, v175
    s_nop 1
    v_cndmask_b32 v175, v1, 0, vcc
    s_add_u32 s30, s25, s41
    s_cmp_eq_u32 s30, 0
    s_cselect_b64 vcc, -1, 0
    v_cndmask_b32 v244, v168, v1, vcc
    v_cndmask_b32 v245, v169, v1, vcc
    v_cndmask_b32 v246, v170, v1, vcc
    v_cndmask_b32 v247, v171, v1, vcc
    v_and_b32 v8, 1, v16
    v_cmp_eq_u32 s[64:65], 1, v8
    v_mov_b32 v8, 0xffff
    v_mov_b32 v1, 0xffff0000
    v_cndmask_b32 v252, v8, v1, s[64:65]
    v_mov_b32 v248, 0x3f803f80
    v_mov_b32 v249, 0x3f803f80
    v_mov_b32 v250, 0x3f803f80
    v_mov_b32 v251, 0x3f803f80
    s_mov_b32 s68, 0x3e8b97f6
    s_mov_b32 s69, 0x3e8b97f6
    s_mul_i32 s29, s40, 10240
    s_add_u32 s29, s29, 139264
    v_add_u32 v8, s29, v13
    s_lshl_b32 s29, s41, 10
    v_add_u32 v19, s29, v8
    s_lshl_b32 s29, s38, 5
    s_lshr_b32 s30, s2, 3
    s_add_u32 s85, s29, s30
    s_min_u32 s29, s85, 111
    s_and_b32 s30, s29, 15
    s_mul_i32 s30, s30, 25088
    s_lshr_b32 s29, s29, 4
    s_lshl_b32 s29, s29, 7
    s_add_u32 s63, s29, s30
    s_add_u32 s90, s10, s63
    s_addc_u32 s91, s11, 0
    v_mov_b32 v112, 0
    v_mov_b32 v113, 0
    v_mov_b32 v114, 0
    v_mov_b32 v115, 0
    v_mov_b32 v116, 0
    v_mov_b32 v117, 0
    v_mov_b32 v118, 0
    v_mov_b32 v119, 0
    v_mov_b32 v120, 0
    v_mov_b32 v121, 0
    v_mov_b32 v122, 0
    v_mov_b32 v123, 0
    v_mov_b32 v124, 0
    v_mov_b32 v125, 0
    v_mov_b32 v126, 0
    v_mov_b32 v127, 0
    v_mov_b32 v128, 0
    v_mov_b32 v129, 0
    v_mov_b32 v130, 0
    v_mov_b32 v131, 0
    v_mov_b32 v132, 0
    v_mov_b32 v133, 0
    v_mov_b32 v134, 0
    v_mov_b32 v135, 0
    v_mov_b32 v136, 0
    v_mov_b32 v137, 0
    v_mov_b32 v138, 0
    v_mov_b32 v139, 0
    v_mov_b32 v140, 0
    v_mov_b32 v141, 0
    v_mov_b32 v142, 0
    v_mov_b32 v143, 0
    v_mov_b32 v144, 0
    v_mov_b32 v145, 0
    v_mov_b32 v146, 0
    v_mov_b32 v147, 0
    v_mov_b32 v148, 0
    v_mov_b32 v149, 0
    v_mov_b32 v150, 0
    v_mov_b32 v151, 0
    v_mov_b32 v152, 0
    v_mov_b32 v153, 0
    v_mov_b32 v154, 0
    v_mov_b32 v155, 0
    v_mov_b32 v156, 0
    v_mov_b32 v157, 0
    v_mov_b32 v158, 0
    v_mov_b32 v159, 0
    s_and_b32 s29, s2, 7
    s_lshl_b32 s30, s29, 10
    v_min_u32 v166, 55, v5
    v_lshlrev_b32 v166, 4, v166
    s_add_u32 s31, s30, 6914048
    s_or_b32 s32, s38, s96
    s_cmp_eq_u32 s32, 0
    s_cselect_b32 s32, s31, 0x7fff0000
    v_add_u32 v166, s32, v166
    s_lshl_b32 s30, s29, 8
    s_add_u32 s30, s30, 6897664
    v_and_b32 v200, 31, v5
    v_lshlrev_b32 v200, 3, v200
    v_add_u32 v200, s30, v200
    s_cmp_lt_u32 s85, 112
    s_cselect_b64 vcc, -1, 0
    v_cndmask_b32 v199, v47, v199, vcc
    buffer_load_dwordx4 v[160:163], v166, s[20:23], 0 offen
    s_mov_b32 s62, 40960
    s_lshl_b32 s35, s34, 7
    s_mul_i32 s36, s34, 172032
    s_cmp_eq_u32 s38, 3
    s_cselect_b32 s37, s35, s36
    s_add_u32 s34, s34, 1
    s_cmp_eq_u32 s34, 7
    s_cselect_b32 s34, 0, s34
    s_add_u32 m0, s52, s62
    s_nop 0
    buffer_load_dwordx4 v20, s[12:15], s35 offen lds
    s_add_u32 m0, s53, s62
    s_nop 0
    buffer_load_dwordx4 v21, s[12:15], s35 offen lds
    s_add_u32 m0, s54, s62
    s_nop 0
    buffer_load_dwordx4 v22, s[12:15], s35 offen lds
    s_add_u32 m0, s55, s62
    s_nop 0
    buffer_load_dwordx4 v23, s[12:15], s35 offen lds
    s_add_u32 m0, s58, s62
    s_nop 0
    buffer_load_dwordx4 v26, s[16:19], s36 offen lds
    s_add_u32 m0, s59, s62
    s_nop 0
    buffer_load_dwordx4 v27, s[16:19], s36 offen lds
    s_add_u32 m0, s60, s62
    s_nop 0
    buffer_load_dwordx4 v28, s[16:19], s36 offen lds
    s_waitcnt vmcnt(8)
    s_branch R_BL
CW_PRO:
    s_and_b32 s29, s2, 7
    v_mov_b32 v96, 0x7fff0000
    v_writelane_b32 v96, 0, 0
    s_or_b32 s94, s27, s96
    s_cmp_eq_u32 s24, 0
    s_cbranch_scc0 CW_B
    s_lshl_b32 s35, s25, 15
    s_lshl_b32 s30, s26, 12
    s_add_u32 s35, s35, s30
    s_add_u32 s35, s35, 4194304
    s_lshl_b32 s36, s29, 15
    s_lshr_b32 s30, s2, 4
    s_lshl_b32 s30, s30, 11
    s_add_u32 s36, s36, s30
    s_and_b32 s30, s2, 8
    s_add_u32 s36, s36, s30
    s_add_u32 s36, s36, 6291456
    s_lshl_b32 s37, s26, 7
    s_lshl_b32 s30, s25, 3
    s_add_u32 s37, s37, s30
    s_add_u32 s37, s37, 6881280
    v_mov_b32 v92, -1
    v_mov_b32 v93, -1
    v_mov_b32 v94, -1
    v_mov_b32 v95, -1
    s_waitcnt lgkmcnt(0)
    s_mov_b32 s20, s8
    s_and_b32 s21, s9, 0xffff
    s_mov_b32 s22, 33554432
    s_mov_b32 s23, 0x00020000
    s_cmp_eq_u32 s94, 0
    s_cbranch_scc0 CW_NE
    buffer_store_dwordx4 v[92:95], v13, s[20:23], s35 offen offset:0 sc0 sc1
    buffer_store_dwordx4 v[92:95], v13, s[20:23], s35 offen offset:1024 sc0 sc1
    buffer_store_dwordx4 v[92:95], v13, s[20:23], s35 offen offset:2048 sc0 sc1
    buffer_store_dwordx4 v[92:95], v13, s[20:23], s35 offen offset:3072 sc0 sc1
    buffer_store_dwordx2 v[92:93], v13, s[20:23], s36 offen offset:0 sc0 sc1
    buffer_store_dwordx2 v[92:93], v13, s[20:23], s36 offen offset:1024 sc0 sc1
CW_NE:
    s_mov_b32 s48, s10
    s_and_b32 s49, s11, 0xffff
    s_mov_b32 s50, 401408
    s_mov_b32 s51, 0x00020000
    s_andn2_b32 s90, s86, 15
    s_sub_u32 s29, s90, 512
    s_subb_u32 s30, s87, 0
    v_mov_b32 v240, s29
    v_mov_b32 v241, s30
    s_or_b32 s90, s90, s88
    s_xor_b32 s90, s90, 0x7f4a7c10
    s_xor_b32 s91, s87, 0x9e3779b9
    v_mov_b32 v242, s90
    v_mov_b32 v243, s91
    s_and_b32 s40, s27, 1
    s_lshl_b32 s41, s27, 1
    s_and_b32 s41, s41, 4
    v_lshrrev_b32 v6, 1, v16
    v_xor_b32 v6, v6, v17
    v_lshlrev_b32 v7, 7, v16
    v_lshl_add_u32 v6, v6, 4, v7
    v_xor_b32 v7, 64, v6
    s_lshl_b32 s29, s41, 11
    v_add_u32 v2, s29, v6
    v_add_u32 v3, s29, v7
    v_lshrrev_b32 v4, 2, v16
    v_lshl_add_u32 v4, v17, 2, v4
    v_mul_u32_u24 v4, 224, v4
    v_and_b32 v8, 3, v16
    v_lshl_add_u32 v4, v8, 3, v4
    s_mul_i32 s29, s40, 56
    s_add_u32 s29, s29, 16384
    v_add_u32 v4, s29, v4
    s_mov_b32 s42, 0
    s_mov_b32 s39, 0
    s_lshl_b32 s31, s26, 1
    s_add_u32 s31, s31, s40
    s_lshl_b32 s29, s41, 2
    s_add_u32 s29, s29, s31
    s_lshl_b32 s29, s29, 12
    s_lshr_b32 s32, s95, 1
    s_lshl_b32 s32, s32, 17
    s_add_u32 s32, s32, 16777216
    s_add_u32 s32, s32, s29
    s_lshl_b32 s29, s31, 1
    s_lshr_b32 s30, s41, 2
    s_add_u32 s29, s29, s30
    s_lshl_b32 s29, s29, 10
    s_lshl_b32 s30, s25, 15
    s_add_u32 s30, s30, 4194304
    s_add_u32 s30, s30, s29
    s_cmp_eq_u32 s96, 0
    s_cselect_b32 s70, s30, s32
    s_bfe_u32 s31, s2, 0x20001
    s_lshl_b32 s31, s31, 3
    s_add_u32 s31, s31, s26
    s_lshr_b32 s29, s31, 1
    s_lshl_b32 s29, s29, 3
    s_add_u32 s29, s29, s27
    s_lshl_b32 s29, s29, 7
    s_add_u32 s29, s29, 6815776
    v_and_b32 v10, 3, v5
    v_lshlrev_b32 v10, 3, v10
    v_add_u32 v10, s29, v10
    s_lshl_b32 s29, s27, 12
    v_add_u32 v12, s29, v13
    v_mov_b32 v9, 0x7fff0000
    s_lshl_b32 s29, s27, 11
    v_add_u32 v15, s29, v13
    s_lshl_b32 s72, s31, 16
    s_add_u32 s73, s72, 16384
    s_add_u32 s74, s72, 32768
    s_add_u32 s75, s72, 49152
    s_bfe_u32 s32, s2, 0x20003
    s_lshl_b32 s29, s31, 6
    v_add_u32 v14, s29, v16
    v_mul_u32_u24 v14, 1792, v14
    v_lshl_add_u32 v14, v17, 3, v14
    s_lshl_b32 s29, s27, 5
    s_mul_i32 s30, s32, 224
    s_add_u32 s29, s29, s30
    v_add_u32 v14, s29, v14
    s_mov_b32 s76, 0
    s_mov_b32 s77, 28672
    s_mov_b32 s78, 57344
    s_mov_b32 s79, 86016
    s_lshl_b32 s29, s27, 2
    s_add_u32 s29, s29, 162816
    v_mov_b32 v30, s29
    v_and_b32 v31, 7, v5
    v_lshlrev_b32 v31, 2, v31
    v_add_u32 v31, 162816, v31
    v_cmp_eq_u32 s[66:67], 3, v17
    s_mov_b32 s68, 0x3fb8aa3b
    s_mov_b32 s69, 0x3fb8aa3b
    v_mov_b32 v248, 0
    v_mov_b32 v249, 0
    v_mov_b32 v250, 0
    v_mov_b32 v251, 0x358637bd
    v_add_u32 v11, 100352, v13
    v_lshlrev_b32 v1, 1, v16
    v_and_b32 v1, 24, v1
    s_lshl_b32 s29, s27, 5
    v_lshl_add_u32 v18, v8, 3, s29
    v_mul_u32_u24 v8, 672, v17
    v_add_u32 v8, v8, v18
    v_mul_u32_u24 v19, 224, v17
    v_add_u32 v18, v19, v8
    s_movk_i32 s30, 224
    s_mov_b32 s29, 0x3020100
    v_bfe_u32 v232, s29, v1, 8
    v_mad_u32_u24 v232, v232, s30, v18
    v_add_u32 v235, 50176, v232
    s_mov_b32 s29, 0x2c121110
    v_bfe_u32 v233, s29, v1, 8
    v_mad_u32_u24 v233, v233, s30, v8
    v_add_u32 v236, 50176, v233
    s_mov_b32 s29, 0x66652e2d
    v_bfe_u32 v234, s29, v1, 8
    v_mad_u32_u24 v234, v234, s30, v8
    v_add_u32 v237, 50176, v234
    v_cmp_le_u32 s[64:65], 12, v16
    v_mov_b32 v252, 0x3f803f80
    s_mul_i32 s30, s32, 224
    v_add_u32 v1, 0, v5
    v_mul_u32_u24 v8, 4682, v1
    v_lshrrev_b32 v8, 16, v8
    v_mul_u32_u24 v8, 672, v8
    v_lshl_add_u32 v224, v1, 4, v8
    v_add_u32 v224, s30, v224
    v_add_u32 v1, 64, v5
    v_mul_u32_u24 v8, 4682, v1
    v_lshrrev_b32 v8, 16, v8
    v_mul_u32_u24 v8, 672, v8
    v_lshl_add_u32 v225, v1, 4, v8
    v_add_u32 v225, s30, v225
    v_add_u32 v1, 128, v5
    v_mul_u32_u24 v8, 4682, v1
    v_lshrrev_b32 v8, 16, v8
    v_mul_u32_u24 v8, 672, v8
    v_lshl_add_u32 v226, v1, 4, v8
    v_add_u32 v226, s30, v226
    v_add_u32 v1, 192, v5
    v_mul_u32_u24 v8, 4682, v1
    v_lshrrev_b32 v8, 16, v8
    v_mul_u32_u24 v8, 672, v8
    v_lshl_add_u32 v227, v1, 4, v8
    v_add_u32 v227, s30, v227
    v_add_u32 v1, 256, v5
    v_mul_u32_u24 v8, 4682, v1
    v_lshrrev_b32 v8, 16, v8
    v_mul_u32_u24 v8, 672, v8
    v_lshl_add_u32 v228, v1, 4, v8
    v_add_u32 v228, s30, v228
    v_add_u32 v1, 320, v5
    v_mul_u32_u24 v8, 4682, v1
    v_lshrrev_b32 v8, 16, v8
    v_mul_u32_u24 v8, 672, v8
    v_lshl_add_u32 v229, v1, 4, v8
    v_add_u32 v229, s30, v229
    v_add_u32 v1, 384, v5
    v_mul_u32_u24 v8, 4682, v1
    v_lshrrev_b32 v8, 16, v8
    v_mul_u32_u24 v8, 672, v8
    v_lshl_add_u32 v230, v1, 4, v8
    v_add_u32 v230, s30, v230
    s_mov_b32 s45, s27
    s_lshl_b32 s29, s26, 2
    s_add_u32 s29, s29, s32
    s_lshl_b32 s30, s29, 10
    s_lshl_b32 s31, s27, 8
    s_add_u32 s30, s30, s31
    s_add_u32 s30, s30, 4194304
    s_and_b32 s31, s32, 1
    s_lshl_b32 s31, s31, 2
    s_add_u32 s31, s31, s27
    s_cmp_eq_u32 s31, 7
    s_cselect_b32 s30, 0x7fff0000, s30
    v_lshlrev_b32 v244, 15, v17
    v_lshl_add_u32 v244, v16, 4, v244
    v_add_u32 v244, s30, v244
    v_mul_u32_u24 v1, 11, v16
    v_lshrrev_b32 v1, 5, v1
    v_add_u32 v1, v1, v16
    v_lshlrev_b32 v8, 2, v16
    v_subrev_u32 v8, 45, v8
    v_cndmask_b32 v1, v1, v8, s[64:65]
    v_add_u32 v1, 64, v1
    v_cmp_lt_u32 vcc, 1, v17
    v_and_b32 v8, 1, v17
    s_lshr_b32 s30, s29, 1
    v_cndmask_b32 v1, v16, v1, vcc
    v_lshlrev_b32 v1, 4, v1
    v_lshl_add_u32 v1, v8, 2, v1
    s_lshl_b32 s30, s30, 11
    s_and_b32 s31, s29, 1
    s_lshl_b32 s31, s31, 3
    s_add_u32 s30, s30, s31
    s_lshl_b32 s31, s27, 8
    s_add_u32 s30, s30, s31
    s_and_b32 s31, s2, 7
    s_lshl_b32 s31, s31, 15
    s_add_u32 s30, s30, s31
    s_add_u32 s30, s30, 6291456
    v_add_u32 v245, s30, v1
    v_mov_b32 v246, 0x3f80
    v_mov_b32 v247, 0x3f800000
    s_lshl_b32 s29, s27, 11
    s_add_u32 s29, s29, 150528
    v_add_u32 v8, s29, v13
    s_xor_b32 s29, s27, 2
    s_lshl_b32 s29, s29, 11
    s_add_u32 s29, s29, 150528
    v_add_u32 v19, s29, v13
    v_mov_b32 v1, 0
    v_mov_b32 v18, 127
    ds_write2_b32 v30, v1, v1 offset0:24 offset1:48
    s_cmp_eq_u32 s96, 0
    s_cselect_b32 s29, 127, 1
    v_mov_b32 v20, s29
    v_mov_b32 v21, 162880
    ds_write_b32 v21, v20
    s_mov_b32 s31, 6881280
    s_cmp_eq_u32 s94, 0
    s_cselect_b32 s30, s31, 0x7fff0000
    v_add_u32 v104, s30, v13
    ds_write2_b32 v30, v18, v1 offset0:32 offset1:40
    v_mov_b32 v112, 0
    v_mov_b32 v113, 0
    v_mov_b32 v114, 0
    v_mov_b32 v115, 0
    v_mov_b32 v116, 0
    v_mov_b32 v117, 0
    v_mov_b32 v118, 0
    v_mov_b32 v119, 0
    v_mov_b32 v120, 0
    v_mov_b32 v121, 0
    v_mov_b32 v122, 0
    v_mov_b32 v123, 0
    v_mov_b32 v124, 0
    v_mov_b32 v125, 0
    v_mov_b32 v126, 0
    v_mov_b32 v127, 0
    v_mov_b32 v128, 0
    v_mov_b32 v129, 0
    v_mov_b32 v130, 0
    v_mov_b32 v131, 0
    v_mov_b32 v132, 0
    v_mov_b32 v133, 0
    v_mov_b32 v134, 0
    v_mov_b32 v135, 0
    v_mov_b32 v136, 0
    v_mov_b32 v137, 0
    v_mov_b32 v138, 0
    v_mov_b32 v139, 0
    v_mov_b32 v140, 0
    v_mov_b32 v141, 0
    v_mov_b32 v142, 0
    v_mov_b32 v143, 0
    v_mov_b32 v144, 0
    v_mov_b32 v145, 0
    v_mov_b32 v146, 0
    v_mov_b32 v147, 0
    v_mov_b32 v148, 0
    v_mov_b32 v149, 0
    v_mov_b32 v150, 0
    v_mov_b32 v151, 0
    v_mov_b32 v152, 0
    v_mov_b32 v153, 0
    v_mov_b32 v154, 0
    v_mov_b32 v155, 0
    v_mov_b32 v156, 0
    v_mov_b32 v157, 0
    v_mov_b32 v158, 0
    v_mov_b32 v159, 0
    v_mov_b32 v160, 0
    v_mov_b32 v161, 0
    v_mov_b32 v162, 0
    v_mov_b32 v163, 0
    v_mov_b32 v164, 0
    v_mov_b32 v165, 0
    v_mov_b32 v166, 0
    v_mov_b32 v167, 0
    v_mov_b32 v168, 0
    v_mov_b32 v169, 0
    v_mov_b32 v170, 0
    v_mov_b32 v171, 0
    v_mov_b32 v172, 0
    v_mov_b32 v173, 0
    v_mov_b32 v174, 0
    v_mov_b32 v175, 0
    s_cmp_eq_u32 s94, 0
    s_cbranch_scc0 R_AK
    s_waitcnt vmcnt(0)
    buffer_store_dwordx2 v[242:243], v96, s[20:23], s37 offen sc0 sc1
    s_branch R_AK
CW_B:
    s_lshl_b32 s34, s29, 8
    s_lshr_b32 s30, s2, 3
    s_lshl_b32 s30, s30, 3
    s_add_u32 s34, s34, s30
    s_add_u32 s34, s34, 6897664
    s_waitcnt lgkmcnt(0)
    s_mov_b32 s20, s8
    s_and_b32 s21, s9, 0xffff
    s_mov_b32 s22, 33554432
    s_mov_b32 s23, 0x00020000
    s_andn2_b32 s90, s86, 15
    s_sub_u32 s29, s90, 512
    s_subb_u32 s30, s87, 0
    v_mov_b32 v240, s29
    v_mov_b32 v241, s30
    s_or_b32 s90, s90, s88
    s_xor_b32 s90, s90, 0x7f4a7c10
    s_xor_b32 s91, s87, 0x9e3779b9
    v_mov_b32 v242, s90
    v_mov_b32 v243, s91
    s_cmp_eq_u32 s94, 0
    s_cbranch_scc0 CW_NS
    buffer_load_dword v253, v96, s[20:23], s34 offen
    buffer_store_dwordx2 v[242:243], v96, s[20:23], s34 offen
CW_NS:
    s_and_b32 s29, s27, 1
    s_bfe_u32 s40, s27, 0x10001
    s_lshl_b32 s41, s29, 1
    v_lshrrev_b32 v6, 1, v16
    v_xor_b32 v6, v6, v17
    v_lshlrev_b32 v7, 7, v16
    v_lshl_add_u32 v6, v6, 4, v7
    v_xor_b32 v7, 64, v6
    s_lshl_b32 s29, s41, 11
    s_add_u32 s29, s29, 2048
    v_add_u32 v2, s29, v6
    v_add_u32 v3, s29, v7
    v_lshrrev_b32 v4, 2, v16
    v_lshl_add_u32 v4, v17, 2, v4
    v_mul_u32_u24 v4, 352, v4
    v_and_b32 v8, 3, v16
    v_lshl_add_u32 v4, v8, 3, v4
    s_mul_i32 s29, s40, 56
    s_add_u32 s29, s29, 18432
    v_add_u32 v4, s29, v4
    s_mov_b32 s42, 0
    s_mov_b32 s39, 0
    s_lshl_b32 s31, s26, 1
    s_add_u32 s31, s31, s40
    s_lshl_b32 s29, s25, 3
    s_add_u32 s29, s29, s41
    s_lshl_b32 s29, s29, 4
    s_add_u32 s29, s29, s31
    s_lshl_b32 s70, s29, 10
    s_add_u32 s70, s70, 2097152
    s_lshl_b32 s29, s25, 3
    s_add_u32 s29, s29, s26
    s_lshl_b32 s29, s29, 7
    s_lshl_b32 s30, s27, 3
    s_add_u32 s29, s29, s30
    s_add_u32 s29, s29, 6832128
    s_cmp_eq_u32 s96, 0
    s_cselect_b32 s29, s29, 0x7fff0000
    v_mov_b32 v9, 0x7fff0000
    v_writelane_b32 v9, s29, 0
    s_bfe_u32 s31, s2, 0x20001
    s_lshl_b32 s31, s31, 3
    s_add_u32 s31, s31, s26
    s_lshr_b32 s29, s31, 1
    s_lshl_b32 s29, s29, 3
    s_add_u32 s29, s29, s27
    s_lshl_b32 s29, s29, 7
    s_and_b32 s30, s31, 1
    s_lshl_b32 s30, s30, 5
    s_add_u32 s29, s29, s30
    s_add_u32 s29, s29, 6832128
    v_and_b32 v10, 3, v5
    v_lshlrev_b32 v10, 3, v10
    v_add_u32 v10, s29, v10
    s_lshl_b32 s29, s27, 12
    v_add_u32 v12, s29, v13
    s_lshl_b32 s29, s27, 11
    v_add_u32 v15, s29, v13
    s_lshl_b32 s72, s31, 16
    s_add_u32 s72, s72, 2097152
    s_add_u32 s73, s72, 16384
    s_add_u32 s74, s72, 32768
    s_add_u32 s75, s72, 49152
    s_bfe_u32 s32, s2, 0x20003
    s_lshl_b32 s29, s31, 6
    v_add_u32 v14, s29, v16
    v_mul_u32_u24 v14, 1792, v14
    v_lshl_add_u32 v14, v17, 3, v14
    s_lshl_b32 s29, s27, 5
    s_mul_i32 s30, s32, 224
    s_add_u32 s29, s29, s30
    s_add_u32 s29, s29, 896
    v_add_u32 v14, s29, v14
    s_mov_b32 s76, 0
    s_mov_b32 s77, 28672
    s_mov_b32 s78, 57344
    s_mov_b32 s79, 86016
    s_lshl_b32 s29, s27, 2
    s_add_u32 s29, s29, 162816
    v_mov_b32 v30, s29
    v_and_b32 v31, 7, v5
    v_lshlrev_b32 v31, 2, v31
    v_add_u32 v31, 162816, v31
    v_cmp_eq_u32 s[66:67], 3, v17
    s_mul_i32 s29, s32, 7
    s_add_u32 s29, s29, s27
    s_lshl_b32 s29, s29, 14
    v_add_u32 v18, s29, v13
    s_and_b32 s29, s2, 7
    s_lshl_b32 s29, s29, 19
    s_add_u32 s71, s29, 9437184
    s_add_u32 s82, s71, 4096
    s_add_u32 s83, s71, 8192
    s_add_u32 s84, s71, 12288
    v_lshlrev_b32 v8, 2, v17
    v_sub_u32 v8, v16, v8
    v_add_u32 v8, 16, v8
    v_mov_b32 v1, 0xcfb2d05e
    v_subrev_u32 v168, 0, v8
    v_alignbit_b32 v168, v168, v168, 1
    v_subrev_u32 v169, 1, v8
    v_alignbit_b32 v169, v169, v169, 1
    v_subrev_u32 v170, 2, v8
    v_alignbit_b32 v170, v170, v170, 1
    v_subrev_u32 v171, 3, v8
    v_alignbit_b32 v171, v171, v171, 1
    v_subrev_u32 v172, 16, v8
    v_alignbit_b32 v172, v172, v172, 1
    v_subrev_u32 v173, 17, v8
    v_alignbit_b32 v173, v173, v173, 1
    v_subrev_u32 v174, 18, v8
    v_alignbit_b32 v174, v174, v174, 1
    v_subrev_u32 v175, 19, v8
    v_alignbit_b32 v175, v175, v175, 1
    v_cmp_ge_u32 vcc, 7, v168
    s_nop 1
    v_cndmask_b32 v168, v1, 0, vcc
    v_cmp_ge_u32 vcc, 7, v169
    s_nop 1
    v_cndmask_b32 v169, v1, 0, vcc
    v_cmp_ge_u32 vcc, 7, v170
    s_nop 1
    v_cndmask_b32 v170, v1, 0, vcc
    v_cmp_ge_u32 vcc, 7, v171
    s_nop 1
    v_cndmask_b32 v171, v1, 0, vcc
    v_cmp_ge_u32 vcc, 7, v172
    s_nop 1
    v_cndmask_b32 v172, v1, 0, vcc
    v_cmp_ge_u32 vcc, 7, v173
    s_nop 1
    v_cndmask_b32 v173, v1, 0, vcc
    v_cmp_ge_u32 vcc, 7, v174
    s_nop 1
    v_cndmask_b32 v174, v1, 0, vcc
    v_cmp_ge_u32 vcc, 7, v175
    s_nop 1
    v_cndmask_b32 v175, v1, 0, vcc
    s_add_u32 s30, s25, s41
    s_cmp_eq_u32 s30, 0
    s_cselect_b64 vcc, -1, 0
    v_cndmask_b32 v244, v168, v1, vcc
    v_cndmask_b32 v245, v169, v1, vcc
    v_cndmask_b32 v246, v170, v1, vcc
    v_cndmask_b32 v247, v171, v1, vcc
    v_and_b32 v8, 1, v16
    v_cmp_eq_u32 s[64:65], 1, v8
    v_mov_b32 v8, 0xffff
    v_mov_b32 v1, 0xffff0000
    v_cndmask_b32 v252, v8, v1, s[64:65]
    v_mov_b32 v248, 0x3f803f80
    v_mov_b32 v249, 0x3f803f80
    v_mov_b32 v250, 0x3f803f80
    v_mov_b32 v251, 0x3f803f80
    s_mov_b32 s68, 0x3e8b97f6
    s_mov_b32 s69, 0x3e8b97f6
    s_mul_i32 s29, s40, 10240
    s_add_u32 s29, s29, 139264
    v_add_u32 v8, s29, v13
    s_lshl_b32 s29, s41, 10
    v_add_u32 v19, s29, v8
    s_lshl_b32 s29, s38, 5
    s_lshr_b32 s30, s2, 3
    s_add_u32 s85, s29, s30
    s_min_u32 s29, s85, 111
    s_and_b32 s30, s29, 15
    s_mul_i32 s30, s30, 25088
    s_lshr_b32 s29, s29, 4
    s_lshl_b32 s29, s29, 7
    s_add_u32 s63, s29, s30
    s_add_u32 s90, s10, s63
    s_addc_u32 s91, s11, 0
    v_mov_b32 v112, 0
    v_mov_b32 v113, 0
    v_mov_b32 v114, 0
    v_mov_b32 v115, 0
    v_mov_b32 v116, 0
    v_mov_b32 v117, 0
    v_mov_b32 v118, 0
    v_mov_b32 v119, 0
    v_mov_b32 v120, 0
    v_mov_b32 v121, 0
    v_mov_b32 v122, 0
    v_mov_b32 v123, 0
    v_mov_b32 v124, 0
    v_mov_b32 v125, 0
    v_mov_b32 v126, 0
    v_mov_b32 v127, 0
    v_mov_b32 v128, 0
    v_mov_b32 v129, 0
    v_mov_b32 v130, 0
    v_mov_b32 v131, 0
    v_mov_b32 v132, 0
    v_mov_b32 v133, 0
    v_mov_b32 v134, 0
    v_mov_b32 v135, 0
    v_mov_b32 v136, 0
    v_mov_b32 v137, 0
    v_mov_b32 v138, 0
    v_mov_b32 v139, 0
    v_mov_b32 v140, 0
    v_mov_b32 v141, 0
    v_mov_b32 v142, 0
    v_mov_b32 v143, 0
    v_mov_b32 v144, 0
    v_mov_b32 v145, 0
    v_mov_b32 v146, 0
    v_mov_b32 v147, 0
    v_mov_b32 v148, 0
    v_mov_b32 v149, 0
    v_mov_b32 v150, 0
    v_mov_b32 v151, 0
    v_mov_b32 v152, 0
    v_mov_b32 v153, 0
    v_mov_b32 v154, 0
    v_mov_b32 v155, 0
    v_mov_b32 v156, 0
    v_mov_b32 v157, 0
    v_mov_b32 v158, 0
    v_mov_b32 v159, 0
    v_mov_b32 v160, 0
    v_mov_b32 v161, 0
    v_mov_b32 v162, 0
    v_mov_b32 v163, 0
    v_mov_b32 v164, 0
    v_mov_b32 v165, 0
    v_mov_b32 v166, 0
    v_mov_b32 v167, 0
    v_lshrrev_b32 v1, 2, v16
    v_lshl_add_u32 v192, v17, 2, v1
    v_min_u32 v193, 2, v17
    v_lshl_add_u32 v193, v193, 2, v1
    v_add_u32 v193, 16, v193
    v_and_b32 v1, 3, v16
    v_lshlrev_b32 v1, 3, v1
    s_lshl_b32 s29, s38, 12
    s_add_u32 s29, s29, 122880
    v_add_u32 v1, s29, v1
    v_lshl_add_u32 v192, v192, 7, v1
    v_lshl_add_u32 v193, v193, 7, v1
    s_and_b32 s29, s2, 7
    s_lshl_b32 s30, s29, 10
    s_add_u32 s31, s30, 6914048
    s_lshl_b32 s32, s85, 3
    s_add_u32 s31, s31, s32
    s_cmp_lt_u32 s85, 112
    s_cselect_b32 s31, s31, 0x7fff0000
    s_cmp_eq_u32 s96, 0
    s_cselect_b32 s31, s31, 0x7fff0000
    v_mov_b32 v195, 0x7fff0000
    v_mov_b32 v194, 0x7fff0000
    v_writelane_b32 v195, s31, 0
    s_lshr_b32 s30, s85, 4
    s_lshl_b32 s30, s30, 16
    s_and_b32 s31, s85, 15
    s_lshl_b32 s31, s31, 10
    s_add_u32 s33, s30, s31
    s_add_u32 s33, s33, s71
    s_cmp_lt_u32 s85, 112
    s_cselect_b64 vcc, -1, 0
    v_cndmask_b32 v194, v194, v13, vcc
    s_bitcmp1_b32 s27, 0
    s_cbranch_scc1 R_BV
    s_branch R_BK
SP_BL:
    s_cmp_eq_u32 s39, 0
    s_cbranch_scc0 SP3_BL
    s_add_u32 s30, s52, 122880
    s_add_u32 m0, s30, 0
    s_nop 0
    buffer_load_dwordx4 v199, s[48:51], s63 offen lds
    s_add_u32 s63, s63, 7168
    s_add_u32 m0, s30, 1024
    s_nop 0
    buffer_load_dwordx4 v199, s[48:51], s63 offen lds
    s_add_u32 s63, s63, 7168
    s_add_u32 m0, s30, 2048
    s_nop 0
    buffer_load_dwordx4 v199, s[48:51], s63 offen lds
    s_add_u32 s63, s63, 7168
    s_mov_b32 exec_hi, 0
    s_add_u32 m0, s30, 3072
    s_nop 0
    buffer_load_dwordx4 v199, s[48:51], s63 offen lds
    s_mov_b32 exec_hi, -1
    v_xor_b32 v196, 0x7f4a7c10, v196
    v_xor_b32 v197, 0x9e3779b9, v197
    v_and_b32 v198, 15, v196
    v_xor_b32 v198, s88, v198
    v_sub_co_u32 v196, vcc, v196, v240
    s_nop 1
    v_subb_co_u32 v197, vcc, v197, v241, vcc
    v_lshrrev_b32 v196, 24, v196
    v_or3_b32 v196, v196, v197, v198
    v_cmp_ne_u32 vcc, 0, v196
    s_nop 4
    s_cmp_eq_u64 vcc, 0
    s_cselect_b32 s92, 1, 0
    s_or_b32 s92, s92, s96
    v_mov_b32 v196, s92
    v_mov_b32 v198, 162880
    s_cmp_eq_u32 s38, 0
    s_cbranch_scc0 SR_BL
    ds_write_b32 v198, v196
    s_branch SR_BL
SP3_BL:
    s_cmp_eq_u32 s92, 0
    s_cbranch_scc1 SL1
    buffer_load_dwordx4 v[160:163], v166, s[20:23], 0 offen sc1
    s_branch SD1
SL1:
    buffer_load_dwordx4 v[160:163], v166, s[20:23], 0 offen sc0 sc1
SD1:
    s_branch SR_BL
GC_BL:
    s_mov_b32 s93, 0
GO_PBL:
    v_xor_b32 v160, 0x7f4a7c10, v160
    v_xor_b32 v161, 0x9e3779b9, v161
    v_sub_co_u32 v160, vcc, v160, v240
    s_nop 1
    v_subb_co_u32 v161, vcc, v161, v241, vcc
    v_lshrrev_b32 v160, 24, v160
    v_or_b32 v160, v160, v161
    v_xor_b32 v162, 0x7f4a7c10, v162
    v_xor_b32 v163, 0x9e3779b9, v163
    v_sub_co_u32 v162, vcc, v162, v240
    s_nop 1
    v_subb_co_u32 v163, vcc, v163, v241, vcc
    v_lshrrev_b32 v162, 24, v162
    v_or_b32 v162, v162, v163
    v_or_b32 v160, v160, v162
    v_cmp_ne_u32 vcc, 0, v160
    s_nop 4
    s_cbranch_vccz GO_OKBL
    s_cmp_eq_u32 s92, 0
    s_cbranch_scc1 SL2
    buffer_load_dwordx4 v[160:163], v166, s[20:23], 0 offen sc1
    s_branch SD2
SL2:
    buffer_load_dwordx4 v[160:163], v166, s[20:23], 0 offen sc0 sc1
SD2:
    s_waitcnt vmcnt(0)
    s_add_u32 s93, s93, 1
    s_cmp_lt_u32 s93, 4000
    s_cbranch_scc1 GO_PBL
    s_mov_b32 s89, 1
    s_branch GO_OKBL
SP_BK:
    s_cmp_eq_u32 s39, 1
    s_cbranch_scc0 SP2_BK
    ds_read_b64_tr_b16 v[176:177], v192 offset:0
    ds_read_b64_tr_b16 v[178:179], v193 offset:0
    ds_read_b64_tr_b16 v[180:181], v192 offset:32
    ds_read_b64_tr_b16 v[182:183], v193 offset:32
    ds_read_b64_tr_b16 v[184:185], v192 offset:64
    ds_read_b64_tr_b16 v[186:187], v193 offset:64
    ds_read_b64_tr_b16 v[188:189], v192 offset:96
    ds_read_b64_tr_b16 v[190:191], v193 offset:96
    s_add_u32 s29, s33, 16384
    s_add_u32 s30, s33, 32768
    s_add_u32 s31, s33, 49152
    s_waitcnt lgkmcnt(6)
    buffer_store_dwordx4 v[176:179], v194, s[20:23], s33 offen sc0 sc1
    s_waitcnt lgkmcnt(4)
    buffer_store_dwordx4 v[180:183], v194, s[20:23], s29 offen sc0 sc1
    s_waitcnt lgkmcnt(2)
    buffer_store_dwordx4 v[184:187], v194, s[20:23], s30 offen sc0 sc1
    s_waitcnt lgkmcnt(0)
    buffer_store_dwordx4 v[188:191], v194, s[20:23], s31 offen sc0 sc1
    s_branch SR_BK
SP2_BK:
    v_mov_b32 v1, 162880
    ds_read_b32 v1, v1
    s_waitcnt vmcnt(0) lgkmcnt(0)
    v_readfirstlane_b32 s92, v1
    s_cmp_eq_u32 s92, 0
    s_cbranch_scc1 SL3
    buffer_store_dwordx2 v[242:243], v195, s[20:23], 0 offen
    s_branch SD3
SL3:
    buffer_store_dwordx2 v[242:243], v195, s[20:23], 0 offen sc0 sc1
SD3:
    s_branch SR_BK
SP_BV:
    s_cmp_eq_u32 s39, 1
    s_cbranch_scc0 SP2_BV
    ds_read_b64_tr_b16 v[176:177], v192 offset:0
    ds_read_b64_tr_b16 v[178:179], v193 offset:0
    ds_read_b64_tr_b16 v[180:181], v192 offset:32
    ds_read_b64_tr_b16 v[182:183], v193 offset:32
    ds_read_b64_tr_b16 v[184:185], v192 offset:64
    ds_read_b64_tr_b16 v[186:187], v193 offset:64
    ds_read_b64_tr_b16 v[188:189], v192 offset:96
    ds_read_b64_tr_b16 v[190:191], v193 offset:96
    s_add_u32 s29, s33, 16384
    s_add_u32 s30, s33, 32768
    s_add_u32 s31, s33, 49152
    s_waitcnt lgkmcnt(6)
    buffer_store_dwordx4 v[176:179], v194, s[20:23], s33 offen sc0 sc1
    s_waitcnt lgkmcnt(4)
    buffer_store_dwordx4 v[180:183], v194, s[20:23], s29 offen sc0 sc1
    s_waitcnt lgkmcnt(2)
    buffer_store_dwordx4 v[184:187], v194, s[20:23], s30 offen sc0 sc1
    s_waitcnt lgkmcnt(0)
    buffer_store_dwordx4 v[188:191], v194, s[20:23], s31 offen sc0 sc1
    s_branch SR_BV
SP2_BV:
    v_mov_b32 v1, 162880
    ds_read_b32 v1, v1
    s_waitcnt vmcnt(0) lgkmcnt(0)
    v_readfirstlane_b32 s92, v1
    s_cmp_eq_u32 s92, 0
    s_cbranch_scc1 SL4
    buffer_store_dwordx2 v[242:243], v195, s[20:23], 0 offen
    s_branch SD4
SL4:
    buffer_store_dwordx2 v[242:243], v195, s[20:23], 0 offen sc0 sc1
SD4:
    s_branch SR_BV
R_AK:
    s_waitcnt lgkmcnt(0)
    s_barrier
    ds_read_b128 v[32:35], v2 offset:0
    ds_read_b128 v[36:39], v2 offset:2048
    ds_read_b128 v[40:43], v2 offset:4096
    ds_read_b128 v[44:47], v2 offset:6144
    ds_read_b64_tr_b16 v[48:49], v4 offset:0
    ds_read_b64_tr_b16 v[50:51], v4 offset:3584
    ds_read_b64_tr_b16 v[52:53], v4 offset:32
    ds_read_b64_tr_b16 v[54:55], v4 offset:3616
    ds_read_b64_tr_b16 v[56:57], v4 offset:112
    ds_read_b64_tr_b16 v[58:59], v4 offset:3696
    ds_read_b64_tr_b16 v[60:61], v4 offset:144
    ds_read_b64_tr_b16 v[62:63], v4 offset:3728
    s_waitcnt lgkmcnt(0)
LP_AK:
    v_mfma_f32_16x16x32_bf16 v[112:115], v[32:35], v[48:51], v[112:115]
    ds_read_b128 v[72:75], v3 offset:0
    v_mfma_f32_16x16x32_bf16 v[120:123], v[36:39], v[48:51], v[120:123]
    ds_read_b128 v[76:79], v3 offset:2048
    v_mfma_f32_16x16x32_bf16 v[128:131], v[40:43], v[48:51], v[128:131]
    ds_read_b128 v[80:83], v3 offset:4096
    v_mfma_f32_16x16x32_bf16 v[136:139], v[44:47], v[48:51], v[136:139]
    ds_read_b128 v[84:87], v3 offset:6144
    v_mfma_f32_16x16x32_bf16 v[116:119], v[32:35], v[52:55], v[116:119]
    ds_read_b64_tr_b16 v[88:89], v4 offset:7168
    v_mfma_f32_16x16x32_bf16 v[124:127], v[36:39], v[52:55], v[124:127]
    ds_read_b64_tr_b16 v[90:91], v4 offset:10752
    v_mfma_f32_16x16x32_bf16 v[132:135], v[40:43], v[52:55], v[132:135]
    ds_read_b64_tr_b16 v[92:93], v4 offset:7200
    v_mfma_f32_16x16x32_bf16 v[140:143], v[44:47], v[52:55], v[140:143]
    ds_read_b64_tr_b16 v[94:95], v4 offset:10784
    v_mfma_f32_16x16x32_bf16 v[144:147], v[32:35], v[56:59], v[144:147]
    ds_read_b64_tr_b16 v[96:97], v4 offset:7280
    v_mfma_f32_16x16x32_bf16 v[152:155], v[36:39], v[56:59], v[152:155]
    ds_read_b64_tr_b16 v[98:99], v4 offset:10864
    v_mfma_f32_16x16x32_bf16 v[160:163], v[40:43], v[56:59], v[160:163]
    ds_read_b64_tr_b16 v[100:101], v4 offset:7312
    v_mfma_f32_16x16x32_bf16 v[168:171], v[44:47], v[56:59], v[168:171]
    ds_read_b64_tr_b16 v[102:103], v4 offset:10896
    v_mfma_f32_16x16x32_bf16 v[148:151], v[32:35], v[60:63], v[148:151]
    v_mfma_f32_16x16x32_bf16 v[156:159], v[36:39], v[60:63], v[156:159]
    v_mfma_f32_16x16x32_bf16 v[164:167], v[40:43], v[60:63], v[164:167]
    v_mfma_f32_16x16x32_bf16 v[172:175], v[44:47], v[60:63], v[172:175]
    s_mov_b32 s43, 30720
    s_cmp_eq_u32 s42, 61440
    s_cselect_b32 s43, -61440, s43
    v_add_u32 v2, s43, v2
    v_add_u32 v3, s43, v3
    v_add_u32 v4, s43, v4
    s_waitcnt lgkmcnt(0)
    s_barrier
    v_mfma_f32_16x16x32_bf16 v[112:115], v[72:75], v[88:91], v[112:115]
    ds_read_b128 v[32:35], v2 offset:0
    v_mfma_f32_16x16x32_bf16 v[120:123], v[76:79], v[88:91], v[120:123]
    ds_read_b128 v[36:39], v2 offset:2048
    v_mfma_f32_16x16x32_bf16 v[128:131], v[80:83], v[88:91], v[128:131]
    ds_read_b128 v[40:43], v2 offset:4096
    v_mfma_f32_16x16x32_bf16 v[136:139], v[84:87], v[88:91], v[136:139]
    ds_read_b128 v[44:47], v2 offset:6144
    v_mfma_f32_16x16x32_bf16 v[116:119], v[72:75], v[92:95], v[116:119]
    ds_read_b64_tr_b16 v[48:49], v4 offset:0
    v_mfma_f32_16x16x32_bf16 v[124:127], v[76:79], v[92:95], v[124:127]
    ds_read_b64_tr_b16 v[50:51], v4 offset:3584
    v_mfma_f32_16x16x32_bf16 v[132:135], v[80:83], v[92:95], v[132:135]
    ds_read_b64_tr_b16 v[52:53], v4 offset:32
    v_mfma_f32_16x16x32_bf16 v[140:143], v[84:87], v[92:95], v[140:143]
    ds_read_b64_tr_b16 v[54:55], v4 offset:3616
    v_mfma_f32_16x16x32_bf16 v[144:147], v[72:75], v[96:99], v[144:147]
    ds_read_b64_tr_b16 v[56:57], v4 offset:112
    v_mfma_f32_16x16x32_bf16 v[152:155], v[76:79], v[96:99], v[152:155]
    ds_read_b64_tr_b16 v[58:59], v4 offset:3696
    v_mfma_f32_16x16x32_bf16 v[160:163], v[80:83], v[96:99], v[160:163]
    ds_read_b64_tr_b16 v[60:61], v4 offset:144
    v_mfma_f32_16x16x32_bf16 v[168:171], v[84:87], v[96:99], v[168:171]
    ds_read_b64_tr_b16 v[62:63], v4 offset:3728
    v_mfma_f32_16x16x32_bf16 v[148:151], v[72:75], v[100:103], v[148:151]
    v_mfma_f32_16x16x32_bf16 v[156:159], v[76:79], v[100:103], v[156:159]
    v_mfma_f32_16x16x32_bf16 v[164:167], v[80:83], v[100:103], v[164:167]
    v_mfma_f32_16x16x32_bf16 v[172:175], v[84:87], v[100:103], v[172:175]
    s_add_u32 s42, s42, s43
    s_add_u32 s39, s39, 1
    s_cmp_lt_u32 s39, 6
    s_waitcnt lgkmcnt(0)
    s_cbranch_scc1 LP_AK
    s_setprio 3
    buffer_load_dwordx4 v[108:111], v104, s[20:23], 0 offen sc0 sc1
    v_mfma_f32_16x16x32_bf16 v[112:115], v[32:35], v[48:51], v[112:115]
    ds_read_b128 v[72:75], v3 offset:0
    ds_read_b128 v[76:79], v3 offset:2048
    v_mfma_f32_16x16x32_bf16 v[116:119], v[32:35], v[52:55], v[116:119]
    ds_read_b128 v[80:83], v3 offset:4096
    ds_read_b128 v[84:87], v3 offset:6144
    v_mfma_f32_16x16x32_bf16 v[120:123], v[36:39], v[48:51], v[120:123]
    ds_read_b64_tr_b16 v[88:89], v4 offset:7168
    ds_read_b64_tr_b16 v[90:91], v4 offset:10752
    v_mfma_f32_16x16x32_bf16 v[124:127], v[36:39], v[52:55], v[124:127]
    ds_read_b64_tr_b16 v[92:93], v4 offset:7200
    ds_read_b64_tr_b16 v[94:95], v4 offset:10784
    v_mfma_f32_16x16x32_bf16 v[128:131], v[40:43], v[48:51], v[128:131]
    ds_read_b64_tr_b16 v[96:97], v4 offset:7280
    ds_read_b64_tr_b16 v[98:99], v4 offset:10864
    v_mfma_f32_16x16x32_bf16 v[132:135], v[40:43], v[52:55], v[132:135]
    ds_read_b64_tr_b16 v[100:101], v4 offset:7312
    ds_read_b64_tr_b16 v[102:103], v4 offset:10896
    v_mfma_f32_16x16x32_bf16 v[136:139], v[44:47], v[48:51], v[136:139]
    v_mfma_f32_16x16x32_bf16 v[140:143], v[44:47], v[52:55], v[140:143]
    s_waitcnt lgkmcnt(0)
    v_mfma_f32_16x16x32_bf16 v[112:115], v[72:75], v[88:91], v[112:115]
    v_mfma_f32_16x16x32_bf16 v[116:119], v[72:75], v[92:95], v[116:119]
    v_mfma_f32_16x16x32_bf16 v[120:123], v[76:79], v[88:91], v[120:123]
    v_mfma_f32_16x16x32_bf16 v[124:127], v[76:79], v[92:95], v[124:127]
    v_mfma_f32_16x16x32_bf16 v[128:131], v[80:83], v[88:91], v[128:131]
    v_mfma_f32_16x16x32_bf16 v[132:135], v[80:83], v[92:95], v[132:135]
    v_mfma_f32_16x16x32_bf16 v[136:139], v[84:87], v[88:91], v[136:139]
    v_pk_mul_f32 v[208:209], v[112:113], s[68:69]
    v_pk_mul_f32 v[210:211], v[114:115], s[68:69]
    v_pk_mul_f32 v[212:213], v[116:117], s[68:69]
    v_mfma_f32_16x16x32_bf16 v[140:143], v[84:87], v[92:95], v[140:143]
    v_pk_mul_f32 v[214:215], v[118:119], s[68:69]
    v_pk_mul_f32 v[216:217], v[120:121], s[68:69]
    v_pk_mul_f32 v[218:219], v[122:123], s[68:69]
    v_mfma_f32_16x16x32_bf16 v[144:147], v[32:35], v[56:59], v[144:147]
    v_pk_mul_f32 v[220:221], v[124:125], s[68:69]
    v_pk_mul_f32 v[222:223], v[126:127], s[68:69]
    v_exp_f32 v208, v208 clamp
    v_mfma_f32_16x16x32_bf16 v[148:151], v[32:35], v[60:63], v[148:151]
    v_exp_f32 v209, v209 clamp
    v_exp_f32 v210, v210 clamp
    v_exp_f32 v211, v211 clamp
    v_mfma_f32_16x16x32_bf16 v[152:155], v[36:39], v[56:59], v[152:155]
    v_exp_f32 v212, v212 clamp
    v_exp_f32 v213, v213 clamp
    v_exp_f32 v214, v214 clamp
    v_mfma_f32_16x16x32_bf16 v[156:159], v[36:39], v[60:63], v[156:159]
    v_exp_f32 v215, v215 clamp
    v_exp_f32 v216, v216 clamp
    v_exp_f32 v217, v217 clamp
    v_mfma_f32_16x16x32_bf16 v[160:163], v[40:43], v[56:59], v[160:163]
    v_exp_f32 v218, v218 clamp
    v_exp_f32 v219, v219 clamp
    v_exp_f32 v220, v220 clamp
    v_mfma_f32_16x16x32_bf16 v[164:167], v[40:43], v[60:63], v[164:167]
    v_exp_f32 v221, v221 clamp
    v_exp_f32 v222, v222 clamp
    v_exp_f32 v223, v223 clamp
    v_mfma_f32_16x16x32_bf16 v[168:171], v[44:47], v[56:59], v[168:171]
    v_max_f32 v112, 0x358637bd, v112
    v_max_f32 v113, 0x358637bd, v113
    v_max_f32 v114, 0x358637bd, v114
    v_mfma_f32_16x16x32_bf16 v[172:175], v[44:47], v[60:63], v[172:175]
    v_max_f32 v115, 0x358637bd, v115
    v_max_f32 v116, 0x358637bd, v116
    v_max_f32 v117, 0x358637bd, v117
    v_mfma_f32_16x16x32_bf16 v[144:147], v[72:75], v[96:99], v[144:147]
    v_max_f32 v118, 0x358637bd, v118
    v_max_f32 v119, 0x358637bd, v119
    v_max_f32 v120, 0x358637bd, v120
    v_mfma_f32_16x16x32_bf16 v[148:151], v[72:75], v[100:103], v[148:151]
    v_max_f32 v121, 0x358637bd, v121
    v_max_f32 v122, 0x358637bd, v122
    v_max_f32 v123, 0x358637bd, v123
    v_mfma_f32_16x16x32_bf16 v[152:155], v[76:79], v[96:99], v[152:155]
    v_max_f32 v124, 0x358637bd, v124
    v_max_f32 v125, 0x358637bd, v125
    v_max_f32 v126, 0x358637bd, v126
    v_mfma_f32_16x16x32_bf16 v[156:159], v[76:79], v[100:103], v[156:159]
    v_max_f32 v127, 0x358637bd, v127
    v_pk_add_f32 v[208:209], v[208:209], v[112:113]
    v_pk_add_f32 v[210:211], v[210:211], v[114:115]
    v_mfma_f32_16x16x32_bf16 v[160:163], v[80:83], v[96:99], v[160:163]
    v_pk_add_f32 v[212:213], v[212:213], v[116:117]
    v_pk_add_f32 v[214:215], v[214:215], v[118:119]
    v_pk_add_f32 v[216:217], v[216:217], v[120:121]
    v_mfma_f32_16x16x32_bf16 v[164:167], v[80:83], v[100:103], v[164:167]
    v_pk_add_f32 v[218:219], v[218:219], v[122:123]
    v_pk_add_f32 v[220:221], v[220:221], v[124:125]
    v_pk_add_f32 v[222:223], v[222:223], v[126:127]
    v_mfma_f32_16x16x32_bf16 v[168:171], v[84:87], v[96:99], v[168:171]
    v_cvt_pk_bf16_f32 v176, v208, v209
    v_cvt_pk_bf16_f32 v177, v210, v211
    v_cvt_pk_bf16_f32 v180, v212, v213
    v_mfma_f32_16x16x32_bf16 v[172:175], v[84:87], v[100:103], v[172:175]
    v_cvt_pk_bf16_f32 v181, v214, v215
    v_cvt_pk_bf16_f32 v178, v216, v217
    v_cvt_pk_bf16_f32 v179, v218, v219
    v_cvt_pk_bf16_f32 v182, v220, v221
    v_cvt_pk_bf16_f32 v183, v222, v223
    s_nop 3
    v_cvt_pk_bf16_f32 v192, v144, v145
    v_cvt_pk_bf16_f32 v193, v146, v147
    v_cvt_pk_bf16_f32 v196, v148, v149
    v_cvt_pk_bf16_f32 v197, v150, v151
    v_cvt_pk_bf16_f32 v194, v152, v153
    v_cvt_pk_bf16_f32 v195, v154, v155
    v_cvt_pk_bf16_f32 v198, v156, v157
    v_cvt_pk_bf16_f32 v199, v158, v159
    v_cndmask_b32 v196, v196, v252, s[64:65]
    v_cndmask_b32 v197, v197, v252, s[64:65]
    v_cndmask_b32 v198, v198, v252, s[64:65]
    v_cndmask_b32 v199, v199, v252, s[64:65]
    s_nop 1
    v_mfma_f32_16x16x32_bf16 v[72:75], v[176:179], v[192:195], 0
    v_mfma_f32_16x16x32_bf16 v[76:79], v[176:179], v[196:199], 0
    v_mfma_f32_16x16x32_bf16 v[80:83], v[180:183], v[192:195], 0
    v_mfma_f32_16x16x32_bf16 v[84:87], v[180:183], v[196:199], 0
    v_pk_mul_f32 v[208:209], v[128:129], s[68:69]
    v_pk_mul_f32 v[210:211], v[130:131], s[68:69]
    v_pk_mul_f32 v[212:213], v[132:133], s[68:69]
    v_pk_mul_f32 v[214:215], v[134:135], s[68:69]
    v_pk_mul_f32 v[216:217], v[136:137], s[68:69]
    v_pk_mul_f32 v[218:219], v[138:139], s[68:69]
    v_pk_mul_f32 v[220:221], v[140:141], s[68:69]
    v_pk_mul_f32 v[222:223], v[142:143], s[68:69]
    v_exp_f32 v208, v208 clamp
    v_exp_f32 v209, v209 clamp
    v_exp_f32 v210, v210 clamp
    v_exp_f32 v211, v211 clamp
    v_exp_f32 v212, v212 clamp
    v_exp_f32 v213, v213 clamp
    v_exp_f32 v214, v214 clamp
    v_exp_f32 v215, v215 clamp
    v_exp_f32 v216, v216 clamp
    v_exp_f32 v217, v217 clamp
    v_exp_f32 v218, v218 clamp
    v_exp_f32 v219, v219 clamp
    v_exp_f32 v220, v220 clamp
    v_exp_f32 v221, v221 clamp
    v_exp_f32 v222, v222 clamp
    v_exp_f32 v223, v223 clamp
    v_max_f32 v128, 0x358637bd, v128
    v_max_f32 v129, 0x358637bd, v129
    v_max_f32 v130, 0x358637bd, v130
    v_max_f32 v131, 0x358637bd, v131
    v_max_f32 v132, 0x358637bd, v132
    v_max_f32 v133, 0x358637bd, v133
    v_max_f32 v134, 0x358637bd, v134
    v_max_f32 v135, 0x358637bd, v135
    v_max_f32 v136, 0x358637bd, v136
    v_max_f32 v137, 0x358637bd, v137
    v_max_f32 v138, 0x358637bd, v138
    v_max_f32 v139, 0x358637bd, v139
    v_max_f32 v140, 0x358637bd, v140
    v_max_f32 v141, 0x358637bd, v141
    v_max_f32 v142, 0x358637bd, v142
    v_max_f32 v143, 0x358637bd, v143
    v_pk_add_f32 v[208:209], v[208:209], v[128:129]
    v_pk_add_f32 v[210:211], v[210:211], v[130:131]
    v_pk_add_f32 v[212:213], v[212:213], v[132:133]
    v_pk_add_f32 v[214:215], v[214:215], v[134:135]
    v_pk_add_f32 v[216:217], v[216:217], v[136:137]
    v_pk_add_f32 v[218:219], v[218:219], v[138:139]
    v_pk_add_f32 v[220:221], v[220:221], v[140:141]
    v_pk_add_f32 v[222:223], v[222:223], v[142:143]
    v_cvt_pk_bf16_f32 v184, v208, v209
    v_cvt_pk_bf16_f32 v185, v210, v211
    v_cvt_pk_bf16_f32 v188, v212, v213
    v_cvt_pk_bf16_f32 v189, v214, v215
    v_cvt_pk_bf16_f32 v186, v216, v217
    v_cvt_pk_bf16_f32 v187, v218, v219
    v_cvt_pk_bf16_f32 v190, v220, v221
    v_cvt_pk_bf16_f32 v191, v222, v223
    v_cvt_pk_bf16_f32 v200, v160, v161
    v_cvt_pk_bf16_f32 v201, v162, v163
    v_cvt_pk_bf16_f32 v204, v164, v165
    v_cvt_pk_bf16_f32 v205, v166, v167
    v_cvt_pk_bf16_f32 v202, v168, v169
    v_cvt_pk_bf16_f32 v203, v170, v171
    v_cvt_pk_bf16_f32 v206, v172, v173
    v_cvt_pk_bf16_f32 v207, v174, v175
    v_cndmask_b32 v204, v204, v252, s[64:65]
    v_cndmask_b32 v205, v205, v252, s[64:65]
    v_cndmask_b32 v206, v206, v252, s[64:65]
    v_cndmask_b32 v207, v207, v252, s[64:65]
    s_mov_b32 s92, 1
    v_mov_b32 v1, 162880
    v_mfma_f32_16x16x32_bf16 v[72:75], v[184:187], v[200:203], v[72:75]
    v_mfma_f32_16x16x32_bf16 v[76:79], v[184:187], v[204:207], v[76:79]
    v_mfma_f32_16x16x32_bf16 v[80:83], v[188:191], v[200:203], v[80:83]
    v_mfma_f32_16x16x32_bf16 v[84:87], v[188:191], v[204:207], v[84:87]
    s_cmp_eq_u32 s96, 0
    s_cbranch_scc1 AK_1
    buffer_load_dwordx4 v[88:91], v13, s[20:23], s70 offen offset:0 sc0 sc1
    buffer_load_dwordx4 v[92:95], v13, s[20:23], s70 offen offset:1024 sc0 sc1
    buffer_load_dwordx4 v[96:99], v13, s[20:23], s70 offen offset:2048 sc0 sc1
    buffer_load_dwordx4 v[100:103], v13, s[20:23], s70 offen offset:3072 sc0 sc1
    s_waitcnt vmcnt(0)
    v_pk_add_f32 v[72:73], v[72:73], v[88:89]
    v_pk_add_f32 v[74:75], v[74:75], v[90:91]
    v_pk_add_f32 v[76:77], v[76:77], v[92:93]
    v_pk_add_f32 v[78:79], v[78:79], v[94:95]
    v_pk_add_f32 v[80:81], v[80:81], v[96:97]
    v_pk_add_f32 v[82:83], v[82:83], v[98:99]
    v_pk_add_f32 v[84:85], v[84:85], v[100:101]
    v_pk_add_f32 v[86:87], v[86:87], v[102:103]
    buffer_store_dwordx4 v[72:75], v13, s[20:23], s70 offen offset:0 sc0 sc1
    buffer_store_dwordx4 v[76:79], v13, s[20:23], s70 offen offset:1024 sc0 sc1
    buffer_store_dwordx4 v[80:83], v13, s[20:23], s70 offen offset:2048 sc0 sc1
    buffer_store_dwordx4 v[84:87], v13, s[20:23], s70 offen offset:3072 sc0 sc1
    s_branch P2
AK_1:
    s_bitcmp1_b32 s27, 1
    s_cbranch_scc1 AK_H1
    s_nop 7
    s_nop 1
    ds_write_b128 v8, v[80:83] offset:0
    ds_write_b128 v8, v[84:87] offset:1024
    s_branch AK_HD
AK_H1:
    s_nop 3
    ds_write_b128 v8, v[72:75] offset:0
    ds_write_b128 v8, v[76:79] offset:1024
    s_nop 3
    v_pk_mov_b32 v[72:73], v[80:81], v[80:81] op_sel:[0,1]
    v_pk_mov_b32 v[74:75], v[82:83], v[82:83] op_sel:[0,1]
    v_pk_mov_b32 v[76:77], v[84:85], v[84:85] op_sel:[0,1]
    v_pk_mov_b32 v[78:79], v[86:87], v[86:87] op_sel:[0,1]
AK_HD:
    ds_write_b32 v30, v18 offset:96
AK_SP:
    ds_read_b32 v21, v31 offset:96
    ds_read_b128 v[88:91], v19 offset:0
    ds_read_b128 v[92:95], v19 offset:1024
    s_waitcnt lgkmcnt(2)
    v_cmp_eq_u32 vcc, 0, v21
    s_nop 3
    s_waitcnt lgkmcnt(0)
    s_cbranch_vccnz AK_SP
    v_pk_add_f32 v[72:73], v[72:73], v[88:89]
    v_pk_add_f32 v[74:75], v[74:75], v[90:91]
    v_pk_add_f32 v[76:77], v[76:77], v[92:93]
    v_pk_add_f32 v[78:79], v[78:79], v[94:95]
    v_cvt_pk_bf16_f32 v72, v72, v73
    v_cvt_pk_bf16_f32 v73, v74, v75
    v_cvt_pk_bf16_f32 v74, v76, v77
    v_cvt_pk_bf16_f32 v75, v78, v79
    buffer_store_dwordx4 v[72:75], v13, s[20:23], s70 offen sc0 sc1
    s_mov_b32 s93, 0
    s_cmp_eq_u32 s27, 0
    s_cbranch_scc0 EA_D
    s_and_b32 s29, s2, 6
    s_lshl_b32 s29, 0x03030303, s29
    s_waitcnt vmcnt(1)
EA_L:
    v_xor_b32 v105, s88, v108
    v_xor_b32 v106, s88, v110
    v_or_b32 v105, v105, v106
    v_and_b32 v105, 15, v105
    v_cmp_ne_u32 vcc, 0, v105
    s_nop 4
    s_or_b32 s30, vcc_lo, vcc_hi
    s_and_b32 s30, s30, s29
    s_cselect_b32 s92, 0, 1
    v_xor_b32 v108, 0x7f4a7c10, v108
    v_xor_b32 v109, 0x9e3779b9, v109
    v_sub_co_u32 v108, vcc, v108, v240
    s_nop 1
    v_subb_co_u32 v109, vcc, v109, v241, vcc
    v_lshrrev_b32 v108, 24, v108
    v_or_b32 v108, v108, v109
    v_xor_b32 v110, 0x7f4a7c10, v110
    v_xor_b32 v111, 0x9e3779b9, v111
    v_sub_co_u32 v110, vcc, v110, v240
    s_nop 1
    v_subb_co_u32 v111, vcc, v111, v241, vcc
    v_lshrrev_b32 v110, 24, v110
    v_or_b32 v110, v110, v111
    v_or_b32 v108, v108, v110
    v_cmp_ne_u32 vcc, 0, v108
    s_nop 4
    s_cbranch_vccz EA_W
EA_X:
    buffer_load_dwordx4 v[108:111], v104, s[20:23], 0 offen sc0 sc1
    s_waitcnt vmcnt(0)
    s_add_u32 s93, s93, 1
    s_cmp_lt_u32 s93, 4000
    s_cbranch_scc1 EA_L
    s_mov_b32 s94, 1
    s_mov_b32 s92, 0
EA_W:
    v_mov_b32 v22, s92
    v_mov_b32 v23, s94
    ds_write_b64 v1, v[22:23]
EA_D:
    s_mov_b32 s93, 0
    s_mov_b32 s35, 131072
    s_mov_b32 s36, 262144
    s_mov_b32 s37, 393216
    s_mul_i32 s29, s45, 7168
    s_mul_i32 s30, s45, 28672
    s_add_u32 s45, s45, 4
    s_add_u32 m0, s29, 0
    s_nop 0
    buffer_load_dwordx4 v224, s[48:51], s30 offen lds
    s_add_u32 m0, s29, 1024
    s_nop 0
    buffer_load_dwordx4 v225, s[48:51], s30 offen lds
    s_add_u32 m0, s29, 2048
    s_nop 0
    buffer_load_dwordx4 v226, s[48:51], s30 offen lds
    s_add_u32 m0, s29, 3072
    s_nop 0
    buffer_load_dwordx4 v227, s[48:51], s30 offen lds
    s_add_u32 m0, s29, 4096
    s_nop 0
    buffer_load_dwordx4 v228, s[48:51], s30 offen lds
    s_add_u32 m0, s29, 5120
    s_nop 0
    buffer_load_dwordx4 v229, s[48:51], s30 offen lds
    s_add_u32 m0, s29, 6144
    s_nop 0
    buffer_load_dwordx4 v230, s[48:51], s30 offen lds
AK_PW:
    ds_read_b64 v[22:23], v1
    s_waitcnt lgkmcnt(0)
    v_readfirstlane_b32 s92, v22
    v_readfirstlane_b32 s94, v23
    s_cmp_gt_u32 s92, 1
    s_cbranch_scc1 AK_PW
    s_or_b32 s89, s89, s94
    s_cmp_eq_u32 s94, 0
    s_cbranch_scc0 P2
    s_mov_b64 s[52:53], -1
    s_mov_b64 s[54:55], -1
    s_mov_b64 s[56:57], -1
    s_mov_b64 s[58:59], -1
RD_RL:
    s_mov_b64 exec, s[52:53]
    buffer_load_dwordx4 v[112:115], v244, s[20:23], 0 offen sc0 sc1
    s_mov_b64 exec, s[54:55]
    buffer_load_dwordx4 v[116:119], v244, s[20:23], s35 offen sc0 sc1
    s_mov_b64 exec, s[56:57]
    buffer_load_dwordx4 v[120:123], v244, s[20:23], s36 offen sc0 sc1
    s_mov_b64 exec, s[58:59]
    buffer_load_dwordx4 v[124:127], v244, s[20:23], s37 offen sc0 sc1
    s_mov_b64 exec, -1
    s_cmp_lt_u32 s45, 8
    s_cbranch_scc0 RD_ND
    s_mul_i32 s29, s45, 7168
    s_mul_i32 s30, s45, 28672
    s_add_u32 s45, s45, 4
    s_add_u32 m0, s29, 0
    s_nop 0
    buffer_load_dwordx4 v224, s[48:51], s30 offen lds
    s_add_u32 m0, s29, 1024
    s_nop 0
    buffer_load_dwordx4 v225, s[48:51], s30 offen lds
    s_add_u32 m0, s29, 2048
    s_nop 0
    buffer_load_dwordx4 v226, s[48:51], s30 offen lds
    s_add_u32 m0, s29, 3072
    s_nop 0
    buffer_load_dwordx4 v227, s[48:51], s30 offen lds
    s_add_u32 m0, s29, 4096
    s_nop 0
    buffer_load_dwordx4 v228, s[48:51], s30 offen lds
    s_add_u32 m0, s29, 5120
    s_nop 0
    buffer_load_dwordx4 v229, s[48:51], s30 offen lds
    s_add_u32 m0, s29, 6144
    s_nop 0
    buffer_load_dwordx4 v230, s[48:51], s30 offen lds
    s_waitcnt vmcnt(7)
    s_branch RD_CK
RD_ND:
    s_waitcnt vmcnt(0)
    ds_write_b32 v30, v18 offset:160
RD_CK:
    v_max3_u32 v128, v112, v113, v114
    v_max3_u32 v129, v116, v117, v118
    v_max3_u32 v130, v120, v121, v122
    v_max3_u32 v131, v124, v125, v126
    v_max_u32 v128, v128, v115
    v_max_u32 v129, v129, v119
    v_max_u32 v130, v130, v123
    v_max_u32 v131, v131, v127
    v_cmp_eq_u32 s[52:53], -1, v128
    v_cmp_eq_u32 s[54:55], -1, v129
    v_cmp_eq_u32 s[56:57], -1, v130
    v_cmp_eq_u32 s[58:59], -1, v131
    s_nop 4
    s_or_b64 s[60:61], s[52:53], s[54:55]
    s_or_b64 s[62:63], s[56:57], s[58:59]
    s_or_b64 s[60:61], s[60:61], s[62:63]
    s_cbranch_scc0 RD_C
    s_add_u32 s93, s93, 1
    s_cmp_lt_u32 s93, 4000
    s_cbranch_scc1 RD_RL
    s_branch P2
RD_C:
    v_dot2_f32_bf16 v128, v112, v246, 0
    v_dot2_f32_bf16 v129, v112, v247, 0
    v_dot2_f32_bf16 v130, v113, v246, 0
    v_dot2_f32_bf16 v131, v113, v247, 0
    v_dot2_f32_bf16 v132, v114, v246, 0
    v_dot2_f32_bf16 v133, v114, v247, 0
    v_dot2_f32_bf16 v134, v115, v246, 0
    v_dot2_f32_bf16 v135, v115, v247, 0
    v_dot2_f32_bf16 v128, v116, v246, v128
    v_dot2_f32_bf16 v129, v116, v247, v129
    v_dot2_f32_bf16 v130, v117, v246, v130
    v_dot2_f32_bf16 v131, v117, v247, v131
    v_dot2_f32_bf16 v132, v118, v246, v132
    v_dot2_f32_bf16 v133, v118, v247, v133
    v_dot2_f32_bf16 v134, v119, v246, v134
    v_dot2_f32_bf16 v135, v119, v247, v135
    v_dot2_f32_bf16 v128, v120, v246, v128
    v_dot2_f32_bf16 v129, v120, v247, v129
    v_dot2_f32_bf16 v130, v121, v246, v130
    v_dot2_f32_bf16 v131, v121, v247, v131
    v_dot2_f32_bf16 v132, v122, v246, v132
    v_dot2_f32_bf16 v133, v122, v247, v133
    v_dot2_f32_bf16 v134, v123, v246, v134
    v_dot2_f32_bf16 v135, v123, v247, v135
    v_dot2_f32_bf16 v128, v124, v246, v128
    v_dot2_f32_bf16 v129, v124, v247, v129
    v_dot2_f32_bf16 v130, v125, v246, v130
    v_dot2_f32_bf16 v131, v125, v247, v131
    v_dot2_f32_bf16 v132, v126, v246, v132
    v_dot2_f32_bf16 v133, v126, v247, v133
    v_dot2_f32_bf16 v134, v127, v246, v134
    v_dot2_f32_bf16 v135, v127, v247, v135
    s_nop 1
    v_permlane32_swap_b32 v128, v132
    v_permlane32_swap_b32 v129, v133
    v_permlane32_swap_b32 v130, v134
    v_permlane32_swap_b32 v131, v135
    s_nop 0
    v_pk_add_f32 v[128:129], v[128:129], v[132:133]
    v_pk_add_f32 v[130:131], v[130:131], v[134:135]
    s_nop 1
    v_permlane16_swap_b32 v128, v130
    v_permlane16_swap_b32 v129, v131
    s_nop 0
    v_pk_add_f32 v[128:129], v[128:129], v[130:131]
    v_cvt_pk_bf16_f32 v128, v128, v129
    s_cmp_eq_u32 s92, 0
    s_cbranch_scc1 SL5
    buffer_store_dword v128, v245, s[20:23], 0 offen
    s_branch SD5
SL5:
    buffer_store_dword v128, v245, s[20:23], 0 offen sc0 sc1
SD5:
    s_branch P2
R_BK:
    s_waitcnt lgkmcnt(0)
    s_barrier
    ds_read_b128 v[32:35], v2 offset:0
    ds_read_b128 v[36:39], v2 offset:2048
    ds_read_b64_tr_b16 v[44:45], v4 offset:0
    ds_read_b64_tr_b16 v[46:47], v4 offset:5632
    ds_read_b64_tr_b16 v[48:49], v4 offset:32
    ds_read_b64_tr_b16 v[50:51], v4 offset:5664
    ds_read_b64_tr_b16 v[52:53], v4 offset:112
    ds_read_b64_tr_b16 v[54:55], v4 offset:5744
    ds_read_b64_tr_b16 v[56:57], v4 offset:144
    ds_read_b64_tr_b16 v[58:59], v4 offset:5776
    ds_read_b64_tr_b16 v[60:61], v4 offset:224
    ds_read_b64_tr_b16 v[62:63], v4 offset:5856
    ds_read_b64_tr_b16 v[64:65], v4 offset:256
    ds_read_b64_tr_b16 v[66:67], v4 offset:5888
    ds_read_b128 v[40:43], v6
    s_waitcnt lgkmcnt(0)
    s_load_dword s93, s[90:91], 0
    s_load_dword s93, s[90:91], 896
    s_load_dword s93, s[90:91], 1792
    s_load_dword s93, s[90:91], 2688
    s_load_dword s93, s[90:91], 3584
    s_load_dword s93, s[90:91], 4480
    s_load_dword s93, s[90:91], 5376
    s_load_dword s93, s[90:91], 6272
    s_load_dword s93, s[90:91], 7168
    s_load_dword s93, s[90:91], 8064
    s_load_dword s93, s[90:91], 8960
    s_load_dword s93, s[90:91], 9856
    s_load_dword s93, s[90:91], 10752
    s_load_dword s93, s[90:91], 11648
LP_BK:
    v_mfma_f32_16x16x32_bf16 v[112:115], v[44:47], v[32:35], v[112:115]
    ds_read_b128 v[72:75], v3 offset:0
    ds_read_b128 v[76:79], v3 offset:2048
    v_mfma_f32_16x16x32_bf16 v[120:123], v[44:47], v[36:39], v[120:123]
    ds_read_b64_tr_b16 v[84:85], v4 offset:11264
    ds_read_b64_tr_b16 v[86:87], v4 offset:16896
    v_mfma_f32_16x16x32_bf16 v[116:119], v[48:51], v[32:35], v[116:119]
    ds_read_b64_tr_b16 v[88:89], v4 offset:11296
    ds_read_b64_tr_b16 v[90:91], v4 offset:16928
    v_mfma_f32_16x16x32_bf16 v[124:127], v[48:51], v[36:39], v[124:127]
    ds_read_b64_tr_b16 v[92:93], v4 offset:11376
    ds_read_b64_tr_b16 v[94:95], v4 offset:17008
    v_mfma_f32_16x16x32_bf16 v[128:131], v[52:55], v[32:35], v[128:131]
    ds_read_b64_tr_b16 v[96:97], v4 offset:11408
    ds_read_b64_tr_b16 v[98:99], v4 offset:17040
    v_mfma_f32_16x16x32_bf16 v[136:139], v[52:55], v[36:39], v[136:139]
    ds_read_b64_tr_b16 v[100:101], v4 offset:11488
    ds_read_b64_tr_b16 v[102:103], v4 offset:17120
    v_mfma_f32_16x16x32_bf16 v[132:135], v[56:59], v[32:35], v[132:135]
    ds_read_b64_tr_b16 v[104:105], v4 offset:11520
    ds_read_b64_tr_b16 v[106:107], v4 offset:17152
    v_mfma_f32_16x16x32_bf16 v[140:143], v[56:59], v[36:39], v[140:143]
    ds_read_b128 v[80:83], v7
    v_mfma_f32_16x16x32_bf16 v[144:147], v[32:35], v[60:63], v[144:147]
    v_mfma_f32_16x16x32_bf16 v[152:155], v[36:39], v[60:63], v[152:155]
    v_mfma_f32_16x16x32_bf16 v[148:151], v[32:35], v[64:67], v[148:151]
    v_mfma_f32_16x16x32_bf16 v[156:159], v[36:39], v[64:67], v[156:159]
    v_mfma_f32_16x16x32_bf16 v[160:163], v[52:55], v[40:43], v[160:163]
    v_mfma_f32_16x16x32_bf16 v[164:167], v[56:59], v[40:43], v[164:167]
    s_mov_b32 s43, 40960
    s_cmp_eq_u32 s42, 81920
    s_cselect_b32 s43, -81920, s43
    v_add_u32 v2, s43, v2
    v_add_u32 v3, s43, v3
    v_add_u32 v4, s43, v4
    v_add_u32 v6, s43, v6
    v_add_u32 v7, s43, v7
    s_waitcnt lgkmcnt(0)
    s_barrier
    s_bitcmp1_b32 10, s39
    s_cbranch_scc1 SP_BK
SR_BK:
    v_mfma_f32_16x16x32_bf16 v[112:115], v[84:87], v[72:75], v[112:115]
    ds_read_b128 v[32:35], v2 offset:0
    ds_read_b128 v[36:39], v2 offset:2048
    v_mfma_f32_16x16x32_bf16 v[120:123], v[84:87], v[76:79], v[120:123]
    ds_read_b64_tr_b16 v[44:45], v4 offset:0
    ds_read_b64_tr_b16 v[46:47], v4 offset:5632
    v_mfma_f32_16x16x32_bf16 v[116:119], v[88:91], v[72:75], v[116:119]
    ds_read_b64_tr_b16 v[48:49], v4 offset:32
    ds_read_b64_tr_b16 v[50:51], v4 offset:5664
    v_mfma_f32_16x16x32_bf16 v[124:127], v[88:91], v[76:79], v[124:127]
    ds_read_b64_tr_b16 v[52:53], v4 offset:112
    ds_read_b64_tr_b16 v[54:55], v4 offset:5744
    v_mfma_f32_16x16x32_bf16 v[128:131], v[92:95], v[72:75], v[128:131]
    ds_read_b64_tr_b16 v[56:57], v4 offset:144
    ds_read_b64_tr_b16 v[58:59], v4 offset:5776
    v_mfma_f32_16x16x32_bf16 v[136:139], v[92:95], v[76:79], v[136:139]
    ds_read_b64_tr_b16 v[60:61], v4 offset:224
    ds_read_b64_tr_b16 v[62:63], v4 offset:5856
    v_mfma_f32_16x16x32_bf16 v[132:135], v[96:99], v[72:75], v[132:135]
    ds_read_b64_tr_b16 v[64:65], v4 offset:256
    ds_read_b64_tr_b16 v[66:67], v4 offset:5888
    v_mfma_f32_16x16x32_bf16 v[140:143], v[96:99], v[76:79], v[140:143]
    ds_read_b128 v[40:43], v6
    v_mfma_f32_16x16x32_bf16 v[144:147], v[72:75], v[100:103], v[144:147]
    v_mfma_f32_16x16x32_bf16 v[152:155], v[76:79], v[100:103], v[152:155]
    v_mfma_f32_16x16x32_bf16 v[148:151], v[72:75], v[104:107], v[148:151]
    v_mfma_f32_16x16x32_bf16 v[156:159], v[76:79], v[104:107], v[156:159]
    v_mfma_f32_16x16x32_bf16 v[160:163], v[92:95], v[80:83], v[160:163]
    v_mfma_f32_16x16x32_bf16 v[164:167], v[96:99], v[80:83], v[164:167]
    s_add_u32 s42, s42, s43
    s_add_u32 s39, s39, 1
    s_cmp_lt_u32 s39, 5
    s_waitcnt lgkmcnt(0)
    s_cbranch_scc1 LP_BK
    v_mfma_f32_16x16x32_bf16 v[112:115], v[44:47], v[32:35], v[112:115]
    ds_read_b128 v[72:75], v3 offset:0
    ds_read_b128 v[76:79], v3 offset:2048
    v_mfma_f32_16x16x32_bf16 v[120:123], v[44:47], v[36:39], v[120:123]
    ds_read_b64_tr_b16 v[84:85], v4 offset:11264
    ds_read_b64_tr_b16 v[86:87], v4 offset:16896
    v_mfma_f32_16x16x32_bf16 v[116:119], v[48:51], v[32:35], v[116:119]
    ds_read_b64_tr_b16 v[88:89], v4 offset:11296
    ds_read_b64_tr_b16 v[90:91], v4 offset:16928
    v_mfma_f32_16x16x32_bf16 v[124:127], v[48:51], v[36:39], v[124:127]
    ds_read_b64_tr_b16 v[92:93], v4 offset:11376
    ds_read_b64_tr_b16 v[94:95], v4 offset:17008
    v_mfma_f32_16x16x32_bf16 v[128:131], v[52:55], v[32:35], v[128:131]
    ds_read_b64_tr_b16 v[96:97], v4 offset:11408
    ds_read_b64_tr_b16 v[98:99], v4 offset:17040
    v_mfma_f32_16x16x32_bf16 v[136:139], v[52:55], v[36:39], v[136:139]
    ds_read_b64_tr_b16 v[100:101], v4 offset:11488
    ds_read_b64_tr_b16 v[102:103], v4 offset:17120
    v_mfma_f32_16x16x32_bf16 v[132:135], v[56:59], v[32:35], v[132:135]
    ds_read_b64_tr_b16 v[104:105], v4 offset:11520
    ds_read_b64_tr_b16 v[106:107], v4 offset:17152
    v_mfma_f32_16x16x32_bf16 v[140:143], v[56:59], v[36:39], v[140:143]
    ds_read_b128 v[80:83], v7
    v_mfma_f32_16x16x32_bf16 v[144:147], v[32:35], v[60:63], v[144:147]
    v_mfma_f32_16x16x32_bf16 v[152:155], v[36:39], v[60:63], v[152:155]
    v_mfma_f32_16x16x32_bf16 v[148:151], v[32:35], v[64:67], v[148:151]
    v_mfma_f32_16x16x32_bf16 v[156:159], v[36:39], v[64:67], v[156:159]
    v_mfma_f32_16x16x32_bf16 v[160:163], v[52:55], v[40:43], v[160:163]
    v_mfma_f32_16x16x32_bf16 v[164:167], v[56:59], v[40:43], v[164:167]
    s_mov_b32 s43, 40960
    s_cmp_eq_u32 s42, 81920
    s_cselect_b32 s43, -81920, s43
    v_add_u32 v2, s43, v2
    v_add_u32 v3, s43, v3
    v_add_u32 v4, s43, v4
    v_add_u32 v6, s43, v6
    v_add_u32 v7, s43, v7
    s_waitcnt lgkmcnt(0)
    s_barrier
    v_mfma_f32_16x16x32_bf16 v[112:115], v[84:87], v[72:75], v[112:115]
    ds_read_b128 v[32:35], v2 offset:0
    ds_read_b128 v[36:39], v2 offset:2048
    buffer_load_dwordx4 v[176:179], v18, s[20:23], s71 offen offset:0 sc0 sc1
    v_mfma_f32_16x16x32_bf16 v[120:123], v[84:87], v[76:79], v[120:123]
    ds_read_b64_tr_b16 v[44:45], v4 offset:0
    ds_read_b64_tr_b16 v[46:47], v4 offset:5632
    buffer_load_dwordx4 v[180:183], v18, s[20:23], s71 offen offset:1024 sc0 sc1
    v_mfma_f32_16x16x32_bf16 v[116:119], v[88:91], v[72:75], v[116:119]
    ds_read_b64_tr_b16 v[48:49], v4 offset:32
    ds_read_b64_tr_b16 v[50:51], v4 offset:5664
    buffer_load_dwordx4 v[184:187], v18, s[20:23], s71 offen offset:2048 sc0 sc1
    v_mfma_f32_16x16x32_bf16 v[124:127], v[88:91], v[76:79], v[124:127]
    ds_read_b64_tr_b16 v[52:53], v4 offset:112
    ds_read_b64_tr_b16 v[54:55], v4 offset:5744
    buffer_load_dwordx4 v[188:191], v18, s[20:23], s71 offen offset:3072 sc0 sc1
    v_mfma_f32_16x16x32_bf16 v[128:131], v[92:95], v[72:75], v[128:131]
    ds_read_b64_tr_b16 v[56:57], v4 offset:144
    ds_read_b64_tr_b16 v[58:59], v4 offset:5776
    buffer_load_dwordx4 v[192:195], v18, s[20:23], s82 offen offset:0 sc0 sc1
    v_mfma_f32_16x16x32_bf16 v[136:139], v[92:95], v[76:79], v[136:139]
    ds_read_b64_tr_b16 v[60:61], v4 offset:224
    ds_read_b64_tr_b16 v[62:63], v4 offset:5856
    buffer_load_dwordx4 v[196:199], v18, s[20:23], s82 offen offset:1024 sc0 sc1
    v_mfma_f32_16x16x32_bf16 v[132:135], v[96:99], v[72:75], v[132:135]
    ds_read_b64_tr_b16 v[64:65], v4 offset:256
    ds_read_b64_tr_b16 v[66:67], v4 offset:5888
    v_mfma_f32_16x16x32_bf16 v[140:143], v[96:99], v[76:79], v[140:143]
    ds_read_b128 v[40:43], v6
    v_mfma_f32_16x16x32_bf16 v[144:147], v[72:75], v[100:103], v[144:147]
    v_mfma_f32_16x16x32_bf16 v[152:155], v[76:79], v[100:103], v[152:155]
    v_mfma_f32_16x16x32_bf16 v[148:151], v[72:75], v[104:107], v[148:151]
    v_mfma_f32_16x16x32_bf16 v[156:159], v[76:79], v[104:107], v[156:159]
    v_mfma_f32_16x16x32_bf16 v[160:163], v[92:95], v[80:83], v[160:163]
    v_mfma_f32_16x16x32_bf16 v[164:167], v[96:99], v[80:83], v[164:167]
    s_waitcnt lgkmcnt(0)
    v_mov_b32 v1, 162880
    v_mfma_f32_16x16x32_bf16 v[112:115], v[44:47], v[32:35], v[112:115]
    ds_read_b128 v[72:75], v3 offset:0
    ds_read_b128 v[76:79], v3 offset:2048
    buffer_load_dwordx4 v[200:203], v18, s[20:23], s82 offen offset:2048 sc0 sc1
    v_mfma_f32_16x16x32_bf16 v[120:123], v[44:47], v[36:39], v[120:123]
    ds_read_b64_tr_b16 v[84:85], v4 offset:11264
    ds_read_b64_tr_b16 v[86:87], v4 offset:16896
    buffer_load_dwordx4 v[204:207], v18, s[20:23], s82 offen offset:3072 sc0 sc1
    v_mfma_f32_16x16x32_bf16 v[116:119], v[48:51], v[32:35], v[116:119]
    ds_read_b64_tr_b16 v[88:89], v4 offset:11296
    ds_read_b64_tr_b16 v[90:91], v4 offset:16928
    buffer_load_dwordx4 v[208:211], v18, s[20:23], s83 offen offset:0 sc0 sc1
    v_mfma_f32_16x16x32_bf16 v[124:127], v[48:51], v[36:39], v[124:127]
    ds_read_b64_tr_b16 v[92:93], v4 offset:11376
    ds_read_b64_tr_b16 v[94:95], v4 offset:17008
    buffer_load_dwordx4 v[212:215], v18, s[20:23], s83 offen offset:1024 sc0 sc1
    v_mfma_f32_16x16x32_bf16 v[128:131], v[52:55], v[32:35], v[128:131]
    ds_read_b64_tr_b16 v[96:97], v4 offset:11408
    ds_read_b64_tr_b16 v[98:99], v4 offset:17040
    buffer_load_dwordx4 v[216:219], v18, s[20:23], s83 offen offset:2048 sc0 sc1
    v_mfma_f32_16x16x32_bf16 v[136:139], v[52:55], v[36:39], v[136:139]
    ds_read_b64_tr_b16 v[100:101], v4 offset:11488
    ds_read_b64_tr_b16 v[102:103], v4 offset:17120
    v_mfma_f32_16x16x32_bf16 v[132:135], v[56:59], v[32:35], v[132:135]
    ds_read_b64_tr_b16 v[104:105], v4 offset:11520
    ds_read_b64_tr_b16 v[106:107], v4 offset:17152
    v_mfma_f32_16x16x32_bf16 v[140:143], v[56:59], v[36:39], v[140:143]
    ds_read_b128 v[80:83], v7
    ds_read_b32 v22, v1
    v_mfma_f32_16x16x32_bf16 v[144:147], v[32:35], v[60:63], v[144:147]
    v_mfma_f32_16x16x32_bf16 v[152:155], v[36:39], v[60:63], v[152:155]
    v_mfma_f32_16x16x32_bf16 v[148:151], v[32:35], v[64:67], v[148:151]
    v_mfma_f32_16x16x32_bf16 v[156:159], v[36:39], v[64:67], v[156:159]
    v_mfma_f32_16x16x32_bf16 v[160:163], v[52:55], v[40:43], v[160:163]
    v_mfma_f32_16x16x32_bf16 v[164:167], v[56:59], v[40:43], v[164:167]
    s_waitcnt lgkmcnt(0)
    s_barrier
    v_readfirstlane_b32 s92, v22
    v_mfma_f32_16x16x32_bf16 v[136:139], v[92:95], v[76:79], v[136:139]
    buffer_load_dwordx4 v[220:223], v18, s[20:23], s83 offen offset:3072 sc0 sc1
    v_mfma_f32_16x16x32_bf16 v[140:143], v[96:99], v[76:79], v[140:143]
    buffer_load_dwordx4 v[224:227], v18, s[20:23], s84 offen offset:0 sc0 sc1
    v_mfma_f32_16x16x32_bf16 v[152:155], v[76:79], v[100:103], v[152:155]
    buffer_load_dwordx4 v[228:231], v18, s[20:23], s84 offen offset:1024 sc0 sc1
    v_mfma_f32_16x16x32_bf16 v[156:159], v[76:79], v[104:107], v[156:159]
    buffer_load_dwordx4 v[232:235], v18, s[20:23], s84 offen offset:2048 sc0 sc1
    v_mfma_f32_16x16x32_bf16 v[160:163], v[92:95], v[80:83], v[160:163]
    buffer_load_dwordx4 v[236:239], v18, s[20:23], s84 offen offset:3072 sc0 sc1
    v_mfma_f32_16x16x32_bf16 v[164:167], v[96:99], v[80:83], v[164:167]
    v_cvt_pk_bf16_f32 v48, v136, v137
    v_cvt_pk_bf16_f32 v49, v138, v139
    v_cvt_pk_bf16_f32 v50, v140, v141
    v_cvt_pk_bf16_f32 v51, v142, v143
    ds_write_b128 v19, v[48:51] offset:2048
    v_mfma_f32_16x16x32_bf16 v[128:131], v[92:95], v[72:75], v[128:131]
    v_mfma_f32_16x16x32_bf16 v[132:135], v[96:99], v[72:75], v[132:135]
    v_cvt_pk_bf16_f32 v56, v152, v153
    v_cvt_pk_bf16_f32 v57, v154, v155
    v_cvt_pk_bf16_f32 v62, v156, v157
    v_cvt_pk_bf16_f32 v63, v158, v159
    ds_write_b64 v19, v[56:57] offset:3072
    ds_write_b64 v19, v[62:63] offset:3080
    v_mfma_f32_16x16x32_bf16 v[120:123], v[84:87], v[76:79], v[120:123]
    v_mfma_f32_16x16x32_bf16 v[124:127], v[88:91], v[76:79], v[124:127]
    v_cvt_pk_bf16_f32 v64, v160, v161
    v_cvt_pk_bf16_f32 v65, v162, v163
    v_cvt_pk_bf16_f32 v66, v164, v165
    v_cvt_pk_bf16_f32 v67, v166, v167
    ds_write_b128 v8, v[64:67] offset:0
    v_mfma_f32_16x16x32_bf16 v[112:115], v[84:87], v[72:75], v[112:115]
    v_mfma_f32_16x16x32_bf16 v[116:119], v[88:91], v[72:75], v[116:119]
    v_cvt_pk_bf16_f32 v44, v128, v129
    v_cvt_pk_bf16_f32 v45, v130, v131
    v_cvt_pk_bf16_f32 v46, v132, v133
    v_cvt_pk_bf16_f32 v47, v134, v135
    v_mfma_f32_16x16x32_bf16 v[144:147], v[72:75], v[100:103], v[144:147]
    v_mfma_f32_16x16x32_bf16 v[148:151], v[72:75], v[104:107], v[148:151]
    v_cvt_pk_bf16_f32 v36, v120, v121
    v_cvt_pk_bf16_f32 v37, v122, v123
    v_cvt_pk_bf16_f32 v38, v124, v125
    v_cvt_pk_bf16_f32 v39, v126, v127
    v_cndmask_b32 v38, v38, 0, s[66:67]
    v_cndmask_b32 v39, v39, 0, s[66:67]
    s_branch B_EPI
R_BV:
    s_waitcnt lgkmcnt(0)
    s_barrier
    ds_read_b128 v[32:35], v2 offset:0
    ds_read_b128 v[36:39], v2 offset:2048
    ds_read_b64_tr_b16 v[44:45], v4 offset:0
    ds_read_b64_tr_b16 v[46:47], v4 offset:5632
    ds_read_b64_tr_b16 v[48:49], v4 offset:32
    ds_read_b64_tr_b16 v[50:51], v4 offset:5664
    ds_read_b64_tr_b16 v[52:53], v4 offset:112
    ds_read_b64_tr_b16 v[54:55], v4 offset:5744
    ds_read_b64_tr_b16 v[56:57], v4 offset:144
    ds_read_b64_tr_b16 v[58:59], v4 offset:5776
    ds_read_b64_tr_b16 v[60:61], v4 offset:224
    ds_read_b64_tr_b16 v[62:63], v4 offset:5856
    ds_read_b64_tr_b16 v[64:65], v4 offset:256
    ds_read_b64_tr_b16 v[66:67], v4 offset:5888
    ds_read_b128 v[40:43], v6
    s_waitcnt lgkmcnt(0)
    s_load_dword s93, s[90:91], 0
    s_load_dword s93, s[90:91], 896
    s_load_dword s93, s[90:91], 1792
    s_load_dword s93, s[90:91], 2688
    s_load_dword s93, s[90:91], 3584
    s_load_dword s93, s[90:91], 4480
    s_load_dword s93, s[90:91], 5376
    s_load_dword s93, s[90:91], 6272
    s_load_dword s93, s[90:91], 7168
    s_load_dword s93, s[90:91], 8064
    s_load_dword s93, s[90:91], 8960
    s_load_dword s93, s[90:91], 9856
    s_load_dword s93, s[90:91], 10752
    s_load_dword s93, s[90:91], 11648
LP_BV:
    v_mfma_f32_16x16x32_bf16 v[112:115], v[44:47], v[32:35], v[112:115]
    ds_read_b128 v[72:75], v3 offset:0
    ds_read_b128 v[76:79], v3 offset:2048
    v_mfma_f32_16x16x32_bf16 v[120:123], v[44:47], v[36:39], v[120:123]
    ds_read_b64_tr_b16 v[84:85], v4 offset:11264
    ds_read_b64_tr_b16 v[86:87], v4 offset:16896
    v_mfma_f32_16x16x32_bf16 v[116:119], v[48:51], v[32:35], v[116:119]
    ds_read_b64_tr_b16 v[88:89], v4 offset:11296
    ds_read_b64_tr_b16 v[90:91], v4 offset:16928
    v_mfma_f32_16x16x32_bf16 v[124:127], v[48:51], v[36:39], v[124:127]
    ds_read_b64_tr_b16 v[92:93], v4 offset:11376
    ds_read_b64_tr_b16 v[94:95], v4 offset:17008
    v_mfma_f32_16x16x32_bf16 v[128:131], v[52:55], v[32:35], v[128:131]
    ds_read_b64_tr_b16 v[96:97], v4 offset:11408
    ds_read_b64_tr_b16 v[98:99], v4 offset:17040
    v_mfma_f32_16x16x32_bf16 v[136:139], v[52:55], v[36:39], v[136:139]
    ds_read_b64_tr_b16 v[100:101], v4 offset:11488
    ds_read_b64_tr_b16 v[102:103], v4 offset:17120
    v_mfma_f32_16x16x32_bf16 v[132:135], v[56:59], v[32:35], v[132:135]
    ds_read_b64_tr_b16 v[104:105], v4 offset:11520
    ds_read_b64_tr_b16 v[106:107], v4 offset:17152
    v_mfma_f32_16x16x32_bf16 v[140:143], v[56:59], v[36:39], v[140:143]
    ds_read_b128 v[80:83], v7
    v_mfma_f32_16x16x32_bf16 v[144:147], v[32:35], v[60:63], v[144:147]
    v_mfma_f32_16x16x32_bf16 v[152:155], v[36:39], v[60:63], v[152:155]
    v_mfma_f32_16x16x32_bf16 v[148:151], v[32:35], v[64:67], v[148:151]
    v_mfma_f32_16x16x32_bf16 v[156:159], v[36:39], v[64:67], v[156:159]
    v_mfma_f32_16x16x32_bf16 v[160:163], v[40:43], v[60:63], v[160:163]
    v_mfma_f32_16x16x32_bf16 v[164:167], v[40:43], v[64:67], v[164:167]
    s_mov_b32 s43, 40960
    s_cmp_eq_u32 s42, 81920
    s_cselect_b32 s43, -81920, s43
    v_add_u32 v2, s43, v2
    v_add_u32 v3, s43, v3
    v_add_u32 v4, s43, v4
    v_add_u32 v6, s43, v6
    v_add_u32 v7, s43, v7
    s_waitcnt lgkmcnt(0)
    s_barrier
    s_bitcmp1_b32 10, s39
    s_cbranch_scc1 SP_BV
SR_BV:
    v_mfma_f32_16x16x32_bf16 v[112:115], v[84:87], v[72:75], v[112:115]
    ds_read_b128 v[32:35], v2 offset:0
    ds_read_b128 v[36:39], v2 offset:2048
    v_mfma_f32_16x16x32_bf16 v[120:123], v[84:87], v[76:79], v[120:123]
    ds_read_b64_tr_b16 v[44:45], v4 offset:0
    ds_read_b64_tr_b16 v[46:47], v4 offset:5632
    v_mfma_f32_16x16x32_bf16 v[116:119], v[88:91], v[72:75], v[116:119]
    ds_read_b64_tr_b16 v[48:49], v4 offset:32
    ds_read_b64_tr_b16 v[50:51], v4 offset:5664
    v_mfma_f32_16x16x32_bf16 v[124:127], v[88:91], v[76:79], v[124:127]
    ds_read_b64_tr_b16 v[52:53], v4 offset:112
    ds_read_b64_tr_b16 v[54:55], v4 offset:5744
    v_mfma_f32_16x16x32_bf16 v[128:131], v[92:95], v[72:75], v[128:131]
    ds_read_b64_tr_b16 v[56:57], v4 offset:144
    ds_read_b64_tr_b16 v[58:59], v4 offset:5776
    v_mfma_f32_16x16x32_bf16 v[136:139], v[92:95], v[76:79], v[136:139]
    ds_read_b64_tr_b16 v[60:61], v4 offset:224
    ds_read_b64_tr_b16 v[62:63], v4 offset:5856
    v_mfma_f32_16x16x32_bf16 v[132:135], v[96:99], v[72:75], v[132:135]
    ds_read_b64_tr_b16 v[64:65], v4 offset:256
    ds_read_b64_tr_b16 v[66:67], v4 offset:5888
    v_mfma_f32_16x16x32_bf16 v[140:143], v[96:99], v[76:79], v[140:143]
    ds_read_b128 v[40:43], v6
    v_mfma_f32_16x16x32_bf16 v[144:147], v[72:75], v[100:103], v[144:147]
    v_mfma_f32_16x16x32_bf16 v[152:155], v[76:79], v[100:103], v[152:155]
    v_mfma_f32_16x16x32_bf16 v[148:151], v[72:75], v[104:107], v[148:151]
    v_mfma_f32_16x16x32_bf16 v[156:159], v[76:79], v[104:107], v[156:159]
    v_mfma_f32_16x16x32_bf16 v[160:163], v[80:83], v[100:103], v[160:163]
    v_mfma_f32_16x16x32_bf16 v[164:167], v[80:83], v[104:107], v[164:167]
    s_add_u32 s42, s42, s43
    s_add_u32 s39, s39, 1
    s_cmp_lt_u32 s39, 5
    s_waitcnt lgkmcnt(0)
    s_cbranch_scc1 LP_BV
    v_mfma_f32_16x16x32_bf16 v[112:115], v[44:47], v[32:35], v[112:115]
    ds_read_b128 v[72:75], v3 offset:0
    ds_read_b128 v[76:79], v3 offset:2048
    v_mfma_f32_16x16x32_bf16 v[120:123], v[44:47], v[36:39], v[120:123]
    ds_read_b64_tr_b16 v[84:85], v4 offset:11264
    ds_read_b64_tr_b16 v[86:87], v4 offset:16896
    v_mfma_f32_16x16x32_bf16 v[116:119], v[48:51], v[32:35], v[116:119]
    ds_read_b64_tr_b16 v[88:89], v4 offset:11296
    ds_read_b64_tr_b16 v[90:91], v4 offset:16928
    v_mfma_f32_16x16x32_bf16 v[124:127], v[48:51], v[36:39], v[124:127]
    ds_read_b64_tr_b16 v[92:93], v4 offset:11376
    ds_read_b64_tr_b16 v[94:95], v4 offset:17008
    v_mfma_f32_16x16x32_bf16 v[128:131], v[52:55], v[32:35], v[128:131]
    ds_read_b64_tr_b16 v[96:97], v4 offset:11408
    ds_read_b64_tr_b16 v[98:99], v4 offset:17040
    v_mfma_f32_16x16x32_bf16 v[136:139], v[52:55], v[36:39], v[136:139]
    ds_read_b64_tr_b16 v[100:101], v4 offset:11488
    ds_read_b64_tr_b16 v[102:103], v4 offset:17120
    v_mfma_f32_16x16x32_bf16 v[132:135], v[56:59], v[32:35], v[132:135]
    ds_read_b64_tr_b16 v[104:105], v4 offset:11520
    ds_read_b64_tr_b16 v[106:107], v4 offset:17152
    v_mfma_f32_16x16x32_bf16 v[140:143], v[56:59], v[36:39], v[140:143]
    ds_read_b128 v[80:83], v7
    v_mfma_f32_16x16x32_bf16 v[144:147], v[32:35], v[60:63], v[144:147]
    v_mfma_f32_16x16x32_bf16 v[152:155], v[36:39], v[60:63], v[152:155]
    v_mfma_f32_16x16x32_bf16 v[148:151], v[32:35], v[64:67], v[148:151]
    v_mfma_f32_16x16x32_bf16 v[156:159], v[36:39], v[64:67], v[156:159]
    v_mfma_f32_16x16x32_bf16 v[160:163], v[40:43], v[60:63], v[160:163]
    v_mfma_f32_16x16x32_bf16 v[164:167], v[40:43], v[64:67], v[164:167]
    s_mov_b32 s43, 40960
    s_cmp_eq_u32 s42, 81920
    s_cselect_b32 s43, -81920, s43
    v_add_u32 v2, s43, v2
    v_add_u32 v3, s43, v3
    v_add_u32 v4, s43, v4
    v_add_u32 v6, s43, v6
    v_add_u32 v7, s43, v7
    s_waitcnt lgkmcnt(0)
    s_barrier
    v_mfma_f32_16x16x32_bf16 v[112:115], v[84:87], v[72:75], v[112:115]
    ds_read_b128 v[32:35], v2 offset:0
    ds_read_b128 v[36:39], v2 offset:2048
    buffer_load_dwordx4 v[176:179], v18, s[20:23], s71 offen offset:0 sc0 sc1
    v_mfma_f32_16x16x32_bf16 v[120:123], v[84:87], v[76:79], v[120:123]
    ds_read_b64_tr_b16 v[44:45], v4 offset:0
    ds_read_b64_tr_b16 v[46:47], v4 offset:5632
    buffer_load_dwordx4 v[180:183], v18, s[20:23], s71 offen offset:1024 sc0 sc1
    v_mfma_f32_16x16x32_bf16 v[116:119], v[88:91], v[72:75], v[116:119]
    ds_read_b64_tr_b16 v[48:49], v4 offset:32
    ds_read_b64_tr_b16 v[50:51], v4 offset:5664
    buffer_load_dwordx4 v[184:187], v18, s[20:23], s71 offen offset:2048 sc0 sc1
    v_mfma_f32_16x16x32_bf16 v[124:127], v[88:91], v[76:79], v[124:127]
    ds_read_b64_tr_b16 v[52:53], v4 offset:112
    ds_read_b64_tr_b16 v[54:55], v4 offset:5744
    buffer_load_dwordx4 v[188:191], v18, s[20:23], s71 offen offset:3072 sc0 sc1
    v_mfma_f32_16x16x32_bf16 v[128:131], v[92:95], v[72:75], v[128:131]
    ds_read_b64_tr_b16 v[56:57], v4 offset:144
    ds_read_b64_tr_b16 v[58:59], v4 offset:5776
    buffer_load_dwordx4 v[192:195], v18, s[20:23], s82 offen offset:0 sc0 sc1
    v_mfma_f32_16x16x32_bf16 v[136:139], v[92:95], v[76:79], v[136:139]
    ds_read_b64_tr_b16 v[60:61], v4 offset:224
    ds_read_b64_tr_b16 v[62:63], v4 offset:5856
    buffer_load_dwordx4 v[196:199], v18, s[20:23], s82 offen offset:1024 sc0 sc1
    v_mfma_f32_16x16x32_bf16 v[132:135], v[96:99], v[72:75], v[132:135]
    ds_read_b64_tr_b16 v[64:65], v4 offset:256
    ds_read_b64_tr_b16 v[66:67], v4 offset:5888
    v_mfma_f32_16x16x32_bf16 v[140:143], v[96:99], v[76:79], v[140:143]
    ds_read_b128 v[40:43], v6
    v_mfma_f32_16x16x32_bf16 v[144:147], v[72:75], v[100:103], v[144:147]
    v_mfma_f32_16x16x32_bf16 v[152:155], v[76:79], v[100:103], v[152:155]
    v_mfma_f32_16x16x32_bf16 v[148:151], v[72:75], v[104:107], v[148:151]
    v_mfma_f32_16x16x32_bf16 v[156:159], v[76:79], v[104:107], v[156:159]
    v_mfma_f32_16x16x32_bf16 v[160:163], v[80:83], v[100:103], v[160:163]
    v_mfma_f32_16x16x32_bf16 v[164:167], v[80:83], v[104:107], v[164:167]
    s_waitcnt lgkmcnt(0)
    v_mov_b32 v1, 162880
    v_mfma_f32_16x16x32_bf16 v[112:115], v[44:47], v[32:35], v[112:115]
    ds_read_b128 v[72:75], v3 offset:0
    ds_read_b128 v[76:79], v3 offset:2048
    buffer_load_dwordx4 v[200:203], v18, s[20:23], s82 offen offset:2048 sc0 sc1
    v_mfma_f32_16x16x32_bf16 v[120:123], v[44:47], v[36:39], v[120:123]
    ds_read_b64_tr_b16 v[84:85], v4 offset:11264
    ds_read_b64_tr_b16 v[86:87], v4 offset:16896
    buffer_load_dwordx4 v[204:207], v18, s[20:23], s82 offen offset:3072 sc0 sc1
    v_mfma_f32_16x16x32_bf16 v[116:119], v[48:51], v[32:35], v[116:119]
    ds_read_b64_tr_b16 v[88:89], v4 offset:11296
    ds_read_b64_tr_b16 v[90:91], v4 offset:16928
    buffer_load_dwordx4 v[208:211], v18, s[20:23], s83 offen offset:0 sc0 sc1
    v_mfma_f32_16x16x32_bf16 v[124:127], v[48:51], v[36:39], v[124:127]
    ds_read_b64_tr_b16 v[92:93], v4 offset:11376
    ds_read_b64_tr_b16 v[94:95], v4 offset:17008
    buffer_load_dwordx4 v[212:215], v18, s[20:23], s83 offen offset:1024 sc0 sc1
    v_mfma_f32_16x16x32_bf16 v[128:131], v[52:55], v[32:35], v[128:131]
    ds_read_b64_tr_b16 v[96:97], v4 offset:11408
    ds_read_b64_tr_b16 v[98:99], v4 offset:17040
    buffer_load_dwordx4 v[216:219], v18, s[20:23], s83 offen offset:2048 sc0 sc1
    v_mfma_f32_16x16x32_bf16 v[136:139], v[52:55], v[36:39], v[136:139]
    ds_read_b64_tr_b16 v[100:101], v4 offset:11488
    ds_read_b64_tr_b16 v[102:103], v4 offset:17120
    v_mfma_f32_16x16x32_bf16 v[132:135], v[56:59], v[32:35], v[132:135]
    ds_read_b64_tr_b16 v[104:105], v4 offset:11520
    ds_read_b64_tr_b16 v[106:107], v4 offset:17152
    v_mfma_f32_16x16x32_bf16 v[140:143], v[56:59], v[36:39], v[140:143]
    ds_read_b128 v[80:83], v7
    ds_read_b32 v22, v1
    v_mfma_f32_16x16x32_bf16 v[144:147], v[32:35], v[60:63], v[144:147]
    v_mfma_f32_16x16x32_bf16 v[152:155], v[36:39], v[60:63], v[152:155]
    v_mfma_f32_16x16x32_bf16 v[148:151], v[32:35], v[64:67], v[148:151]
    v_mfma_f32_16x16x32_bf16 v[156:159], v[36:39], v[64:67], v[156:159]
    v_mfma_f32_16x16x32_bf16 v[160:163], v[40:43], v[60:63], v[160:163]
    v_mfma_f32_16x16x32_bf16 v[164:167], v[40:43], v[64:67], v[164:167]
    s_waitcnt lgkmcnt(0)
    s_barrier
    v_readfirstlane_b32 s92, v22
    v_mfma_f32_16x16x32_bf16 v[136:139], v[92:95], v[76:79], v[136:139]
    buffer_load_dwordx4 v[220:223], v18, s[20:23], s83 offen offset:3072 sc0 sc1
    v_mfma_f32_16x16x32_bf16 v[140:143], v[96:99], v[76:79], v[140:143]
    buffer_load_dwordx4 v[224:227], v18, s[20:23], s84 offen offset:0 sc0 sc1
    v_mfma_f32_16x16x32_bf16 v[152:155], v[76:79], v[100:103], v[152:155]
    buffer_load_dwordx4 v[228:231], v18, s[20:23], s84 offen offset:1024 sc0 sc1
    v_mfma_f32_16x16x32_bf16 v[156:159], v[76:79], v[104:107], v[156:159]
    buffer_load_dwordx4 v[232:235], v18, s[20:23], s84 offen offset:2048 sc0 sc1
    v_mfma_f32_16x16x32_bf16 v[160:163], v[80:83], v[100:103], v[160:163]
    buffer_load_dwordx4 v[236:239], v18, s[20:23], s84 offen offset:3072 sc0 sc1
    v_mfma_f32_16x16x32_bf16 v[164:167], v[80:83], v[104:107], v[164:167]
    v_cvt_pk_bf16_f32 v48, v136, v137
    v_cvt_pk_bf16_f32 v49, v138, v139
    v_cvt_pk_bf16_f32 v50, v140, v141
    v_cvt_pk_bf16_f32 v51, v142, v143
    ds_write_b128 v19, v[48:51] offset:2048
    v_mfma_f32_16x16x32_bf16 v[128:131], v[92:95], v[72:75], v[128:131]
    v_mfma_f32_16x16x32_bf16 v[132:135], v[96:99], v[72:75], v[132:135]
    v_cvt_pk_bf16_f32 v56, v152, v153
    v_cvt_pk_bf16_f32 v57, v154, v155
    v_cvt_pk_bf16_f32 v62, v156, v157
    v_cvt_pk_bf16_f32 v63, v158, v159
    ds_write_b64 v19, v[56:57] offset:3072
    ds_write_b64 v19, v[62:63] offset:3080
    v_mfma_f32_16x16x32_bf16 v[120:123], v[84:87], v[76:79], v[120:123]
    v_mfma_f32_16x16x32_bf16 v[124:127], v[88:91], v[76:79], v[124:127]
    v_cvt_pk_bf16_f32 v64, v160, v161
    v_cvt_pk_bf16_f32 v65, v162, v163
    v_cvt_pk_bf16_f32 v66, v164, v165
    v_cvt_pk_bf16_f32 v67, v166, v167
    ds_write_b128 v8, v[64:67] offset:1024
    v_mfma_f32_16x16x32_bf16 v[112:115], v[84:87], v[72:75], v[112:115]
    v_mfma_f32_16x16x32_bf16 v[116:119], v[88:91], v[72:75], v[116:119]
    v_cvt_pk_bf16_f32 v44, v128, v129
    v_cvt_pk_bf16_f32 v45, v130, v131
    v_cvt_pk_bf16_f32 v46, v132, v133
    v_cvt_pk_bf16_f32 v47, v134, v135
    v_mfma_f32_16x16x32_bf16 v[144:147], v[72:75], v[100:103], v[144:147]
    v_mfma_f32_16x16x32_bf16 v[148:151], v[72:75], v[104:107], v[148:151]
    v_cvt_pk_bf16_f32 v36, v120, v121
    v_cvt_pk_bf16_f32 v37, v122, v123
    v_cvt_pk_bf16_f32 v38, v124, v125
    v_cvt_pk_bf16_f32 v39, v126, v127
    v_cndmask_b32 v38, v38, 0, s[66:67]
    v_cndmask_b32 v39, v39, 0, s[66:67]
    s_branch B_EPI
R_BL:
    s_waitcnt lgkmcnt(0)
    s_barrier
    ds_read_b128 v[32:35], v2 offset:0
    ds_read_b128 v[36:39], v2 offset:2048
    ds_read_b64_tr_b16 v[44:45], v4 offset:0
    ds_read_b64_tr_b16 v[46:47], v4 offset:5632
    ds_read_b64_tr_b16 v[48:49], v4 offset:32
    ds_read_b64_tr_b16 v[50:51], v4 offset:5664
    ds_read_b64_tr_b16 v[52:53], v4 offset:112
    ds_read_b64_tr_b16 v[54:55], v4 offset:5744
    ds_read_b64_tr_b16 v[56:57], v4 offset:144
    ds_read_b64_tr_b16 v[58:59], v4 offset:5776
    ds_read_b64_tr_b16 v[60:61], v4 offset:224
    ds_read_b64_tr_b16 v[62:63], v4 offset:5856
    ds_read_b64_tr_b16 v[64:65], v4 offset:256
    ds_read_b64_tr_b16 v[66:67], v4 offset:5888
    s_waitcnt lgkmcnt(0)
    s_load_dword s93, s[90:91], 12544
    s_load_dword s93, s[90:91], 13440
    s_load_dword s93, s[90:91], 14336
    s_load_dword s93, s[90:91], 15232
    s_load_dword s93, s[90:91], 16128
    s_load_dword s93, s[90:91], 17024
    s_load_dword s93, s[90:91], 17920
    s_load_dword s93, s[90:91], 18816
    s_load_dword s93, s[90:91], 19712
    s_load_dword s93, s[90:91], 20608
    s_load_dword s93, s[90:91], 21504
    s_load_dword s93, s[90:91], 22400
    s_load_dword s93, s[90:91], 23296
    s_load_dword s93, s[90:91], 24192
    s_add_u32 m0, s61, s62
    s_nop 0
    buffer_load_dwordx4 v29, s[16:19], s36 offen lds
    s_add_u32 m0, s56, s62
    s_nop 0
    buffer_load_dwordx4 v24, s[44:47], s37 offen lds
    s_add_u32 m0, s57, s62
    s_nop 0
    buffer_load_dwordx4 v25, s[44:47], s37 offen lds
    buffer_load_dwordx2 v[196:197], v200, s[20:23], 0 offen sc1
    s_mov_b32 s62, 81920
LP_BL:
    v_mfma_f32_16x16x32_bf16 v[112:115], v[44:47], v[32:35], v[112:115]
    ds_read_b128 v[72:75], v3 offset:0
    ds_read_b128 v[76:79], v3 offset:2048
    s_lshl_b32 s35, s34, 7
    s_mul_i32 s36, s34, 172032
    s_cmp_eq_u32 s38, 3
    s_cselect_b32 s37, s35, s36
    s_add_u32 s34, s34, 1
    s_cmp_eq_u32 s34, 7
    s_cselect_b32 s34, 0, s34
    s_add_u32 m0, s52, s62
    v_mfma_f32_16x16x32_bf16 v[120:123], v[44:47], v[36:39], v[120:123]
    ds_read_b64_tr_b16 v[84:85], v4 offset:11264
    ds_read_b64_tr_b16 v[86:87], v4 offset:16896
    buffer_load_dwordx4 v20, s[12:15], s35 offen lds
    s_add_u32 m0, s53, s62
    v_mfma_f32_16x16x32_bf16 v[116:119], v[48:51], v[32:35], v[116:119]
    ds_read_b64_tr_b16 v[88:89], v4 offset:11296
    ds_read_b64_tr_b16 v[90:91], v4 offset:16928
    buffer_load_dwordx4 v21, s[12:15], s35 offen lds
    s_add_u32 m0, s54, s62
    v_mfma_f32_16x16x32_bf16 v[124:127], v[48:51], v[36:39], v[124:127]
    ds_read_b64_tr_b16 v[92:93], v4 offset:11376
    ds_read_b64_tr_b16 v[94:95], v4 offset:17008
    buffer_load_dwordx4 v22, s[12:15], s35 offen lds
    s_add_u32 m0, s55, s62
    v_mfma_f32_16x16x32_bf16 v[128:131], v[52:55], v[32:35], v[128:131]
    ds_read_b64_tr_b16 v[96:97], v4 offset:11408
    ds_read_b64_tr_b16 v[98:99], v4 offset:17040
    buffer_load_dwordx4 v23, s[12:15], s35 offen lds
    s_add_u32 m0, s58, s62
    v_mfma_f32_16x16x32_bf16 v[136:139], v[52:55], v[36:39], v[136:139]
    ds_read_b64_tr_b16 v[100:101], v4 offset:11488
    ds_read_b64_tr_b16 v[102:103], v4 offset:17120
    buffer_load_dwordx4 v26, s[16:19], s36 offen lds
    s_add_u32 m0, s59, s62
    v_mfma_f32_16x16x32_bf16 v[132:135], v[56:59], v[32:35], v[132:135]
    ds_read_b64_tr_b16 v[104:105], v4 offset:11520
    ds_read_b64_tr_b16 v[106:107], v4 offset:17152
    buffer_load_dwordx4 v27, s[16:19], s36 offen lds
    s_add_u32 m0, s60, s62
    v_mfma_f32_16x16x32_bf16 v[140:143], v[56:59], v[36:39], v[140:143]
    buffer_load_dwordx4 v28, s[16:19], s36 offen lds
    v_mfma_f32_16x16x32_bf16 v[144:147], v[32:35], v[60:63], v[144:147]
    v_mfma_f32_16x16x32_bf16 v[152:155], v[36:39], v[60:63], v[152:155]
    v_mfma_f32_16x16x32_bf16 v[148:151], v[32:35], v[64:67], v[148:151]
    v_mfma_f32_16x16x32_bf16 v[156:159], v[36:39], v[64:67], v[156:159]
    s_mov_b32 s43, 40960
    s_cmp_eq_u32 s42, 81920
    s_cselect_b32 s43, -81920, s43
    v_add_u32 v2, s43, v2
    v_add_u32 v3, s43, v3
    v_add_u32 v4, s43, v4
    s_waitcnt lgkmcnt(0) vmcnt(7)
    s_barrier
    s_bitcmp1_b32 17, s39
    s_cbranch_scc1 SP_BL
SR_BL:
    v_mfma_f32_16x16x32_bf16 v[112:115], v[84:87], v[72:75], v[112:115]
    ds_read_b128 v[32:35], v2 offset:0
    ds_read_b128 v[36:39], v2 offset:2048
    s_add_u32 m0, s61, s62
    v_mfma_f32_16x16x32_bf16 v[120:123], v[84:87], v[76:79], v[120:123]
    ds_read_b64_tr_b16 v[44:45], v4 offset:0
    ds_read_b64_tr_b16 v[46:47], v4 offset:5632
    buffer_load_dwordx4 v29, s[16:19], s36 offen lds
    s_add_u32 m0, s56, s62
    v_mfma_f32_16x16x32_bf16 v[116:119], v[88:91], v[72:75], v[116:119]
    ds_read_b64_tr_b16 v[48:49], v4 offset:32
    ds_read_b64_tr_b16 v[50:51], v4 offset:5664
    buffer_load_dwordx4 v24, s[44:47], s37 offen lds
    s_add_u32 m0, s57, s62
    v_mfma_f32_16x16x32_bf16 v[124:127], v[88:91], v[76:79], v[124:127]
    ds_read_b64_tr_b16 v[52:53], v4 offset:112
    ds_read_b64_tr_b16 v[54:55], v4 offset:5744
    buffer_load_dwordx4 v25, s[44:47], s37 offen lds
    v_mfma_f32_16x16x32_bf16 v[128:131], v[92:95], v[72:75], v[128:131]
    ds_read_b64_tr_b16 v[56:57], v4 offset:144
    ds_read_b64_tr_b16 v[58:59], v4 offset:5776
    v_mfma_f32_16x16x32_bf16 v[136:139], v[92:95], v[76:79], v[136:139]
    ds_read_b64_tr_b16 v[60:61], v4 offset:224
    ds_read_b64_tr_b16 v[62:63], v4 offset:5856
    v_mfma_f32_16x16x32_bf16 v[132:135], v[96:99], v[72:75], v[132:135]
    ds_read_b64_tr_b16 v[64:65], v4 offset:256
    ds_read_b64_tr_b16 v[66:67], v4 offset:5888
    v_mfma_f32_16x16x32_bf16 v[140:143], v[96:99], v[76:79], v[140:143]
    v_mfma_f32_16x16x32_bf16 v[144:147], v[72:75], v[100:103], v[144:147]
    v_mfma_f32_16x16x32_bf16 v[152:155], v[76:79], v[100:103], v[152:155]
    v_mfma_f32_16x16x32_bf16 v[148:151], v[72:75], v[104:107], v[148:151]
    v_mfma_f32_16x16x32_bf16 v[156:159], v[76:79], v[104:107], v[156:159]
    s_mov_b32 s62, s42
    s_add_u32 s42, s42, s43
    s_add_u32 s39, s39, 1
    s_cmp_lt_u32 s39, 5
    s_waitcnt lgkmcnt(0)
    s_cbranch_scc1 LP_BL
    v_mfma_f32_16x16x32_bf16 v[112:115], v[44:47], v[32:35], v[112:115]
    ds_read_b128 v[72:75], v3 offset:0
    ds_read_b128 v[76:79], v3 offset:2048
    v_mfma_f32_16x16x32_bf16 v[120:123], v[44:47], v[36:39], v[120:123]
    ds_read_b64_tr_b16 v[84:85], v4 offset:11264
    ds_read_b64_tr_b16 v[86:87], v4 offset:16896
    v_mfma_f32_16x16x32_bf16 v[116:119], v[48:51], v[32:35], v[116:119]
    ds_read_b64_tr_b16 v[88:89], v4 offset:11296
    ds_read_b64_tr_b16 v[90:91], v4 offset:16928
    v_mfma_f32_16x16x32_bf16 v[124:127], v[48:51], v[36:39], v[124:127]
    ds_read_b64_tr_b16 v[92:93], v4 offset:11376
    ds_read_b64_tr_b16 v[94:95], v4 offset:17008
    v_mfma_f32_16x16x32_bf16 v[128:131], v[52:55], v[32:35], v[128:131]
    ds_read_b64_tr_b16 v[96:97], v4 offset:11408
    ds_read_b64_tr_b16 v[98:99], v4 offset:17040
    v_mfma_f32_16x16x32_bf16 v[136:139], v[52:55], v[36:39], v[136:139]
    ds_read_b64_tr_b16 v[100:101], v4 offset:11488
    ds_read_b64_tr_b16 v[102:103], v4 offset:17120
    v_mfma_f32_16x16x32_bf16 v[132:135], v[56:59], v[32:35], v[132:135]
    ds_read_b64_tr_b16 v[104:105], v4 offset:11520
    ds_read_b64_tr_b16 v[106:107], v4 offset:17152
    v_mfma_f32_16x16x32_bf16 v[140:143], v[56:59], v[36:39], v[140:143]
    v_mfma_f32_16x16x32_bf16 v[144:147], v[32:35], v[60:63], v[144:147]
    v_mfma_f32_16x16x32_bf16 v[152:155], v[36:39], v[60:63], v[152:155]
    v_mfma_f32_16x16x32_bf16 v[148:151], v[32:35], v[64:67], v[148:151]
    v_mfma_f32_16x16x32_bf16 v[156:159], v[36:39], v[64:67], v[156:159]
    s_mov_b32 s43, 40960
    s_cmp_eq_u32 s42, 81920
    s_cselect_b32 s43, -81920, s43
    v_add_u32 v2, s43, v2
    v_add_u32 v3, s43, v3
    v_add_u32 v4, s43, v4
    s_waitcnt vmcnt(0)
    s_or_b32 s29, s38, s96
    s_cmp_eq_u32 s29, 0
    s_cbranch_scc1 GC_BL
GO_OKBL:
    s_waitcnt lgkmcnt(0)
    s_barrier
    v_mfma_f32_16x16x32_bf16 v[112:115], v[84:87], v[72:75], v[112:115]
    ds_read_b128 v[32:35], v2 offset:0
    ds_read_b128 v[36:39], v2 offset:2048
    buffer_load_dwordx4 v[176:179], v18, s[20:23], s71 offen offset:0 sc0 sc1
    v_mfma_f32_16x16x32_bf16 v[120:123], v[84:87], v[76:79], v[120:123]
    ds_read_b64_tr_b16 v[44:45], v4 offset:0
    ds_read_b64_tr_b16 v[46:47], v4 offset:5632
    buffer_load_dwordx4 v[180:183], v18, s[20:23], s71 offen offset:1024 sc0 sc1
    v_mfma_f32_16x16x32_bf16 v[116:119], v[88:91], v[72:75], v[116:119]
    ds_read_b64_tr_b16 v[48:49], v4 offset:32
    ds_read_b64_tr_b16 v[50:51], v4 offset:5664
    buffer_load_dwordx4 v[184:187], v18, s[20:23], s71 offen offset:2048 sc0 sc1
    v_mfma_f32_16x16x32_bf16 v[124:127], v[88:91], v[76:79], v[124:127]
    ds_read_b64_tr_b16 v[52:53], v4 offset:112
    ds_read_b64_tr_b16 v[54:55], v4 offset:5744
    buffer_load_dwordx4 v[188:191], v18, s[20:23], s71 offen offset:3072 sc0 sc1
    v_mfma_f32_16x16x32_bf16 v[128:131], v[92:95], v[72:75], v[128:131]
    ds_read_b64_tr_b16 v[56:57], v4 offset:144
    ds_read_b64_tr_b16 v[58:59], v4 offset:5776
    buffer_load_dwordx4 v[192:195], v18, s[20:23], s82 offen offset:0 sc0 sc1
    v_mfma_f32_16x16x32_bf16 v[136:139], v[92:95], v[76:79], v[136:139]
    ds_read_b64_tr_b16 v[60:61], v4 offset:224
    ds_read_b64_tr_b16 v[62:63], v4 offset:5856
    buffer_load_dwordx4 v[196:199], v18, s[20:23], s82 offen offset:1024 sc0 sc1
    v_mfma_f32_16x16x32_bf16 v[132:135], v[96:99], v[72:75], v[132:135]
    ds_read_b64_tr_b16 v[64:65], v4 offset:256
    ds_read_b64_tr_b16 v[66:67], v4 offset:5888
    v_mfma_f32_16x16x32_bf16 v[140:143], v[96:99], v[76:79], v[140:143]
    v_mfma_f32_16x16x32_bf16 v[144:147], v[72:75], v[100:103], v[144:147]
    v_mfma_f32_16x16x32_bf16 v[152:155], v[76:79], v[100:103], v[152:155]
    v_mfma_f32_16x16x32_bf16 v[148:151], v[72:75], v[104:107], v[148:151]
    v_mfma_f32_16x16x32_bf16 v[156:159], v[76:79], v[104:107], v[156:159]
    s_waitcnt lgkmcnt(0)
    v_mov_b32 v1, 162880
    v_mfma_f32_16x16x32_bf16 v[112:115], v[44:47], v[32:35], v[112:115]
    ds_read_b128 v[72:75], v3 offset:0
    ds_read_b128 v[76:79], v3 offset:2048
    buffer_load_dwordx4 v[200:203], v18, s[20:23], s82 offen offset:2048 sc0 sc1
    v_mfma_f32_16x16x32_bf16 v[120:123], v[44:47], v[36:39], v[120:123]
    ds_read_b64_tr_b16 v[84:85], v4 offset:11264
    ds_read_b64_tr_b16 v[86:87], v4 offset:16896
    buffer_load_dwordx4 v[204:207], v18, s[20:23], s82 offen offset:3072 sc0 sc1
    v_mfma_f32_16x16x32_bf16 v[116:119], v[48:51], v[32:35], v[116:119]
    ds_read_b64_tr_b16 v[88:89], v4 offset:11296
    ds_read_b64_tr_b16 v[90:91], v4 offset:16928
    buffer_load_dwordx4 v[208:211], v18, s[20:23], s83 offen offset:0 sc0 sc1
    v_mfma_f32_16x16x32_bf16 v[124:127], v[48:51], v[36:39], v[124:127]
    ds_read_b64_tr_b16 v[92:93], v4 offset:11376
    ds_read_b64_tr_b16 v[94:95], v4 offset:17008
    buffer_load_dwordx4 v[212:215], v18, s[20:23], s83 offen offset:1024 sc0 sc1
    v_mfma_f32_16x16x32_bf16 v[128:131], v[52:55], v[32:35], v[128:131]
    ds_read_b64_tr_b16 v[96:97], v4 offset:11408
    ds_read_b64_tr_b16 v[98:99], v4 offset:17040
    buffer_load_dwordx4 v[216:219], v18, s[20:23], s83 offen offset:2048 sc0 sc1
    v_mfma_f32_16x16x32_bf16 v[136:139], v[52:55], v[36:39], v[136:139]
    ds_read_b64_tr_b16 v[100:101], v4 offset:11488
    ds_read_b64_tr_b16 v[102:103], v4 offset:17120
    v_mfma_f32_16x16x32_bf16 v[132:135], v[56:59], v[32:35], v[132:135]
    ds_read_b64_tr_b16 v[104:105], v4 offset:11520
    ds_read_b64_tr_b16 v[106:107], v4 offset:17152
    v_mfma_f32_16x16x32_bf16 v[140:143], v[56:59], v[36:39], v[140:143]
    ds_read_b32 v22, v1
    v_mfma_f32_16x16x32_bf16 v[144:147], v[32:35], v[60:63], v[144:147]
    v_mfma_f32_16x16x32_bf16 v[152:155], v[36:39], v[60:63], v[152:155]
    v_mfma_f32_16x16x32_bf16 v[148:151], v[32:35], v[64:67], v[148:151]
    v_mfma_f32_16x16x32_bf16 v[156:159], v[36:39], v[64:67], v[156:159]
    s_waitcnt lgkmcnt(0)
    s_barrier
    v_readfirstlane_b32 s92, v22
    v_mfma_f32_16x16x32_bf16 v[136:139], v[92:95], v[76:79], v[136:139]
    buffer_load_dwordx4 v[220:223], v18, s[20:23], s83 offen offset:3072 sc0 sc1
    v_mfma_f32_16x16x32_bf16 v[140:143], v[96:99], v[76:79], v[140:143]
    buffer_load_dwordx4 v[224:227], v18, s[20:23], s84 offen offset:0 sc0 sc1
    v_mfma_f32_16x16x32_bf16 v[152:155], v[76:79], v[100:103], v[152:155]
    buffer_load_dwordx4 v[228:231], v18, s[20:23], s84 offen offset:1024 sc0 sc1
    v_mfma_f32_16x16x32_bf16 v[156:159], v[76:79], v[104:107], v[156:159]
    buffer_load_dwordx4 v[232:235], v18, s[20:23], s84 offen offset:2048 sc0 sc1
    v_mfma_f32_16x16x32_bf16 v[128:131], v[92:95], v[72:75], v[128:131]
    buffer_load_dwordx4 v[236:239], v18, s[20:23], s84 offen offset:3072 sc0 sc1
    v_mfma_f32_16x16x32_bf16 v[132:135], v[96:99], v[72:75], v[132:135]
    v_cvt_pk_bf16_f32 v48, v136, v137
    v_cvt_pk_bf16_f32 v49, v138, v139
    v_cvt_pk_bf16_f32 v50, v140, v141
    v_cvt_pk_bf16_f32 v51, v142, v143
    ds_write_b128 v19, v[48:51] offset:2048
    v_mfma_f32_16x16x32_bf16 v[120:123], v[84:87], v[76:79], v[120:123]
    v_mfma_f32_16x16x32_bf16 v[124:127], v[88:91], v[76:79], v[124:127]
    v_cvt_pk_bf16_f32 v56, v152, v153
    v_cvt_pk_bf16_f32 v57, v154, v155
    v_cvt_pk_bf16_f32 v62, v156, v157
    v_cvt_pk_bf16_f32 v63, v158, v159
    ds_write_b64 v19, v[56:57] offset:3072
    ds_write_b64 v19, v[62:63] offset:3080
    v_mfma_f32_16x16x32_bf16 v[112:115], v[84:87], v[72:75], v[112:115]
    v_mfma_f32_16x16x32_bf16 v[116:119], v[88:91], v[72:75], v[116:119]
    v_cvt_pk_bf16_f32 v44, v128, v129
    v_cvt_pk_bf16_f32 v45, v130, v131
    v_cvt_pk_bf16_f32 v46, v132, v133
    v_cvt_pk_bf16_f32 v47, v134, v135
    v_mfma_f32_16x16x32_bf16 v[144:147], v[72:75], v[100:103], v[144:147]
    v_mfma_f32_16x16x32_bf16 v[148:151], v[72:75], v[104:107], v[148:151]
    v_cvt_pk_bf16_f32 v36, v120, v121
    v_cvt_pk_bf16_f32 v37, v122, v123
    v_cvt_pk_bf16_f32 v38, v124, v125
    v_cvt_pk_bf16_f32 v39, v126, v127
    v_cndmask_b32 v38, v38, 0, s[66:67]
    v_cndmask_b32 v39, v39, 0, s[66:67]
B_EPI:
    s_setprio 0
    s_waitcnt lgkmcnt(0)
    s_barrier
    ds_read_b128 v[40:43], v19
    ds_read_b64 v[52:53], v19 offset:1024
    ds_read_b64 v[58:59], v19 offset:1032
    v_mfma_f32_16x16x32_bf16 v[92:95], v[44:47], v[36:39], v[168:171]
    v_mfma_f32_16x16x32_bf16 v[96:99], v[48:51], v[36:39], v[172:175]
    v_cvt_pk_bf16_f32 v32, v112, v113
    v_cvt_pk_bf16_f32 v33, v114, v115
    v_cvt_pk_bf16_f32 v34, v116, v117
    v_cvt_pk_bf16_f32 v35, v118, v119
    v_cndmask_b32 v34, v34, 0, s[66:67]
    v_cndmask_b32 v35, v35, 0, s[66:67]
    v_cvt_pk_bf16_f32 v54, v144, v145
    v_cvt_pk_bf16_f32 v55, v146, v147
    v_cvt_pk_bf16_f32 v60, v148, v149
    v_cvt_pk_bf16_f32 v61, v150, v151
    v_mfma_f32_16x16x32_bf16 v[76:79], v[44:47], v[32:35], v[172:175]
    s_waitcnt lgkmcnt(2)
    v_mfma_f32_16x16x32_bf16 v[72:75], v[40:43], v[32:35], v[244:247]
    v_cndmask_b32 v100, v92, v93, s[64:65]
    v_cndmask_b32 v101, v94, v95, s[64:65]
    v_cndmask_b32 v102, v96, v97, s[64:65]
    v_cndmask_b32 v103, v98, v99, s[64:65]
    v_max3_f32 v104, v100, v101, v102
    v_max_f32 v104, v104, v103
    s_nop 3
    v_cndmask_b32 v82, v76, v77, s[64:65]
    v_cndmask_b32 v83, v78, v79, s[64:65]
    v_cndmask_b32 v80, v72, v73, s[64:65]
    v_cndmask_b32 v81, v74, v75, s[64:65]
    v_max3_f32 v84, v80, v81, v82
    v_max_f32 v84, v84, v83
    v_mov_b32 v105, v104
    v_mov_b32 v85, v84
    s_nop 0
    v_permlane32_swap_b32 v104, v105
    v_permlane32_swap_b32 v84, v85
    s_nop 0
    v_max_f32 v104, v104, v105
    v_max_f32 v84, v84, v85
    v_mov_b32 v105, v104
    v_mov_b32 v85, v84
    s_nop 0
    v_permlane16_swap_b32 v104, v105
    v_permlane16_swap_b32 v84, v85
    s_nop 0
    v_max_f32 v104, v104, v105
    v_max_f32 v84, v84, v85
    v_mul_f32 v104, s68, v104
    v_mul_f32 v84, s68, v84
    v_pk_fma_f32 v[100:101], v[100:101], s[68:69], v[104:105] op_sel_hi:[1,1,0] neg_lo:[0,0,1] neg_hi:[0,0,1]
    v_pk_fma_f32 v[80:81], v[80:81], s[68:69], v[84:85] op_sel_hi:[1,1,0] neg_lo:[0,0,1] neg_hi:[0,0,1]
    v_pk_fma_f32 v[102:103], v[102:103], s[68:69], v[104:105] op_sel_hi:[1,1,0] neg_lo:[0,0,1] neg_hi:[0,0,1]
    v_pk_fma_f32 v[82:83], v[82:83], s[68:69], v[84:85] op_sel_hi:[1,1,0] neg_lo:[0,0,1] neg_hi:[0,0,1]
    v_exp_f32 v100, v100
    v_exp_f32 v101, v101
    v_exp_f32 v102, v102
    v_exp_f32 v103, v103
    v_exp_f32 v80, v80
    v_exp_f32 v81, v81
    v_exp_f32 v82, v82
    v_exp_f32 v83, v83
    v_cvt_pk_bf16_f32 v100, v100, v100
    v_cvt_pk_bf16_f32 v101, v101, v101
    v_cvt_pk_bf16_f32 v102, v102, v102
    v_cvt_pk_bf16_f32 v103, v103, v103
    v_and_b32 v100, v252, v100
    v_and_b32 v101, v252, v101
    v_and_b32 v102, v252, v102
    v_and_b32 v103, v252, v103
    s_waitcnt lgkmcnt(0)
    s_nop 1
    v_mfma_f32_16x16x32_bf16 v[108:111], v[248:251], v[100:103], 0
    v_mfma_f32_16x16x32_bf16 v[92:95], v[54:57], v[100:103], 0
    v_mfma_f32_16x16x32_bf16 v[96:99], v[60:63], v[100:103], 0
    v_cvt_pk_bf16_f32 v80, v80, v80
    v_cvt_pk_bf16_f32 v81, v81, v81
    v_cvt_pk_bf16_f32 v82, v82, v82
    v_cvt_pk_bf16_f32 v83, v83, v83
    v_and_b32 v80, v252, v80
    v_and_b32 v81, v252, v81
    v_and_b32 v82, v252, v82
    v_and_b32 v83, v252, v83
    s_waitcnt lgkmcnt(0)
    s_nop 1
    v_mfma_f32_16x16x32_bf16 v[88:91], v[248:251], v[80:83], 0
    v_mfma_f32_16x16x32_bf16 v[72:75], v[52:55], v[80:83], 0
    v_mfma_f32_16x16x32_bf16 v[76:79], v[58:61], v[80:83], 0
    s_add_u32 s29, s70, 16384
    s_nop 2
    v_rcp_f32 v108, v108
    s_nop 7
    v_rcp_f32 v88, v88
    v_pk_mul_f32 v[92:93], v[92:93], v[108:109] op_sel_hi:[1,0]
    v_pk_mul_f32 v[94:95], v[94:95], v[108:109] op_sel_hi:[1,0]
    v_pk_mul_f32 v[96:97], v[96:97], v[108:109] op_sel_hi:[1,0]
    v_pk_mul_f32 v[98:99], v[98:99], v[108:109] op_sel_hi:[1,0]
    v_cvt_pk_bf16_f32 v36, v92, v93
    v_cvt_pk_bf16_f32 v37, v94, v95
    v_cvt_pk_bf16_f32 v38, v96, v97
    v_cvt_pk_bf16_f32 v39, v98, v99
    v_cndmask_b32 v38, v38, 0, s[66:67]
    v_cndmask_b32 v39, v39, 0, s[66:67]
    buffer_store_dwordx4 v[36:39], v13, s[20:23], s29 offen sc0 sc1
    s_nop 1
    v_pk_mul_f32 v[72:73], v[72:73], v[88:89] op_sel_hi:[1,0]
    v_pk_mul_f32 v[74:75], v[74:75], v[88:89] op_sel_hi:[1,0]
    v_pk_mul_f32 v[76:77], v[76:77], v[88:89] op_sel_hi:[1,0]
    v_pk_mul_f32 v[78:79], v[78:79], v[88:89] op_sel_hi:[1,0]
    v_cvt_pk_bf16_f32 v32, v72, v73
    v_cvt_pk_bf16_f32 v33, v74, v75
    v_cvt_pk_bf16_f32 v34, v76, v77
    v_cvt_pk_bf16_f32 v35, v78, v79
    v_cndmask_b32 v34, v34, 0, s[66:67]
    v_cndmask_b32 v35, v35, 0, s[66:67]
    buffer_store_dwordx4 v[32:35], v13, s[20:23], s70 offen sc0 sc1
P2:
    s_setprio 0
    s_cmp_eq_u32 s96, 0
    s_cbranch_scc1 P2N
    s_waitcnt vmcnt(0) lgkmcnt(0)
    s_barrier
    s_add_u32 s97, s97, 1
    s_cmp_eq_u32 s97, 128
    s_cbranch_scc1 P2N
    s_add_u32 s2, s2, 2
    s_and_b32 s2, s2, 255
    s_branch RESTART
P2N:
    s_mov_b32 s16, s80
    s_and_b32 s17, s81, 0xffff
    s_mov_b32 s18, 3670016
    s_mov_b32 s19, 0x00020000
    s_lshl_b32 s34, s27, 11
    s_mov_b32 s93, 0
    s_cmp_eq_u32 s24, 0
    s_cbranch_scc1 P2_A
    s_waitcnt vmcnt(0)
    s_cmp_eq_u32 s92, 0
    s_cbranch_scc1 SL6
    buffer_store_dwordx2 v[242:243], v9, s[20:23], 0 offen
    s_branch SD6
SL6:
    buffer_store_dwordx2 v[242:243], v9, s[20:23], 0 offen sc0 sc1
SD6:
    s_cmp_eq_u32 s96, 0
    s_cbranch_scc0 PB_GO
PB_POLL:
    s_cmp_eq_u32 s92, 0
    s_cbranch_scc1 SL7
    buffer_load_dwordx2 v[20:21], v10, s[20:23], 0 offen sc1
    s_branch SD7
SL7:
    buffer_load_dwordx2 v[20:21], v10, s[20:23], 0 offen sc0 sc1
SD7:
    s_waitcnt vmcnt(0)
    v_xor_b32 v20, 0x7f4a7c10, v20
    v_xor_b32 v21, 0x9e3779b9, v21
    v_sub_co_u32 v20, vcc, v20, v240
    s_nop 1
    v_subb_co_u32 v21, vcc, v21, v241, vcc
    v_lshrrev_b32 v20, 24, v20
    v_or_b32 v20, v20, v21
    v_cmp_ne_u32 vcc, 0, v20
    s_nop 4
    s_cbranch_vccz PB_GO
    s_add_u32 s93, s93, 1
    s_cmp_lt_u32 s93, 4000
    s_cbranch_scc1 PB_POLL
    s_mov_b32 s89, 1
    s_branch PB_ND
PB_GO:
    s_cmp_eq_u32 s92, 0
    s_cbranch_scc1 SL8
    s_add_u32 m0, s34, 0
    s_nop 0
    buffer_load_dwordx4 v15, s[20:23], s72 offen offset:0 sc1 lds
    buffer_load_dwordx4 v15, s[20:23], s72 offen offset:1024 sc1 lds
    s_add_u32 m0, s34, 16384
    s_nop 0
    buffer_load_dwordx4 v15, s[20:23], s73 offen offset:0 sc1 lds
    buffer_load_dwordx4 v15, s[20:23], s73 offen offset:1024 sc1 lds
    s_add_u32 m0, s34, 32768
    s_nop 0
    buffer_load_dwordx4 v15, s[20:23], s74 offen offset:0 sc1 lds
    buffer_load_dwordx4 v15, s[20:23], s74 offen offset:1024 sc1 lds
    s_add_u32 m0, s34, 49152
    s_nop 0
    buffer_load_dwordx4 v15, s[20:23], s75 offen offset:0 sc1 lds
    buffer_load_dwordx4 v15, s[20:23], s75 offen offset:1024 sc1 lds
    s_branch SD8
SL8:
    s_add_u32 m0, s34, 0
    s_nop 0
    buffer_load_dwordx4 v15, s[20:23], s72 offen offset:0 sc0 sc1 lds
    buffer_load_dwordx4 v15, s[20:23], s72 offen offset:1024 sc0 sc1 lds
    s_add_u32 m0, s34, 16384
    s_nop 0
    buffer_load_dwordx4 v15, s[20:23], s73 offen offset:0 sc0 sc1 lds
    buffer_load_dwordx4 v15, s[20:23], s73 offen offset:1024 sc0 sc1 lds
    s_add_u32 m0, s34, 32768
    s_nop 0
    buffer_load_dwordx4 v15, s[20:23], s74 offen offset:0 sc0 sc1 lds
    buffer_load_dwordx4 v15, s[20:23], s74 offen offset:1024 sc0 sc1 lds
    s_add_u32 m0, s34, 49152
    s_nop 0
    buffer_load_dwordx4 v15, s[20:23], s75 offen offset:0 sc0 sc1 lds
    buffer_load_dwordx4 v15, s[20:23], s75 offen offset:1024 sc0 sc1 lds
SD8:
PB_ND:
    s_cmp_eq_u32 s27, 7
    s_cselect_b32 s29, 127, 0
    v_mov_b32 v29, s89
    v_mov_b32 v28, s29
    ds_write2_b32 v30, v29, v28 offset0:0 offset1:56
    s_waitcnt vmcnt(6) lgkmcnt(0)
    s_barrier
    s_cmp_eq_u32 s27, 7
    s_cbranch_scc1 PB_W7
    ds_read_b32 v29, v31
    ds_read_b128 v[32:35], v13 offset:0
    ds_read_b128 v[36:39], v13 offset:1024
    ds_read_b128 v[40:43], v13 offset:2048
    ds_read_b128 v[44:47], v13 offset:3072
    ds_read_b128 v[48:51], v13 offset:4096
    ds_read_b128 v[52:55], v13 offset:5120
    ds_read_b128 v[56:59], v13 offset:6144
    ds_read_b128 v[60:63], v13 offset:7168
    ds_read_b128 v[64:67], v13 offset:8192
    ds_read_b128 v[68:71], v13 offset:9216
    ds_read_b128 v[72:75], v13 offset:10240
    ds_read_b128 v[76:79], v13 offset:11264
    ds_read_b128 v[80:83], v13 offset:12288
    ds_read_b128 v[84:87], v13 offset:13312
    ds_read_b128 v[88:91], v13 offset:14336
    ds_read_b128 v[92:95], v13 offset:15360
    s_waitcnt lgkmcnt(15)
    v_cmp_ne_u32 vcc, 0, v29
    s_nop 4
    s_cbranch_vccnz FALLBACK
    s_waitcnt vmcnt(4)
    s_barrier
    s_waitcnt lgkmcnt(15)
    v_mfma_f32_16x16x32_bf16 v[160:163], v[176:179], v[32:35], 0
    ds_read_b128 v[96:99], v13 offset:16384
    s_waitcnt lgkmcnt(15)
    v_mfma_f32_16x16x32_bf16 v[160:163], v[180:183], v[36:39], v[160:163]
    ds_read_b128 v[100:103], v13 offset:17408
    s_waitcnt lgkmcnt(15)
    v_mfma_f32_16x16x32_bf16 v[160:163], v[184:187], v[40:43], v[160:163]
    ds_read_b128 v[104:107], v13 offset:18432
    s_waitcnt lgkmcnt(15)
    v_mfma_f32_16x16x32_bf16 v[160:163], v[188:191], v[44:47], v[160:163]
    ds_read_b128 v[108:111], v13 offset:19456
    s_waitcnt lgkmcnt(15)
    v_mfma_f32_16x16x32_bf16 v[160:163], v[192:195], v[48:51], v[160:163]
    ds_read_b128 v[112:115], v13 offset:20480
    s_waitcnt lgkmcnt(15)
    v_mfma_f32_16x16x32_bf16 v[160:163], v[196:199], v[52:55], v[160:163]
    ds_read_b128 v[116:119], v13 offset:21504
    s_waitcnt lgkmcnt(15)
    v_mfma_f32_16x16x32_bf16 v[160:163], v[200:203], v[56:59], v[160:163]
    ds_read_b128 v[120:123], v13 offset:22528
    s_waitcnt lgkmcnt(15)
    v_mfma_f32_16x16x32_bf16 v[160:163], v[204:207], v[60:63], v[160:163]
    ds_read_b128 v[124:127], v13 offset:23552
    s_waitcnt lgkmcnt(15)
    v_mfma_f32_16x16x32_bf16 v[160:163], v[208:211], v[64:67], v[160:163]
    ds_read_b128 v[128:131], v13 offset:24576
    s_waitcnt lgkmcnt(15)
    v_mfma_f32_16x16x32_bf16 v[160:163], v[212:215], v[68:71], v[160:163]
    ds_read_b128 v[132:135], v13 offset:25600
    s_waitcnt lgkmcnt(15)
    v_mfma_f32_16x16x32_bf16 v[160:163], v[216:219], v[72:75], v[160:163]
    ds_read_b128 v[136:139], v13 offset:26624
    s_waitcnt lgkmcnt(15)
    v_mfma_f32_16x16x32_bf16 v[160:163], v[220:223], v[76:79], v[160:163]
    ds_read_b128 v[140:143], v13 offset:27648
    s_waitcnt lgkmcnt(15)
    v_mfma_f32_16x16x32_bf16 v[160:163], v[224:227], v[80:83], v[160:163]
    ds_read_b128 v[144:147], v13 offset:28672
    s_waitcnt lgkmcnt(15)
    v_mfma_f32_16x16x32_bf16 v[160:163], v[228:231], v[84:87], v[160:163]
    ds_read_b128 v[148:151], v13 offset:29696
    s_waitcnt lgkmcnt(15)
    v_mfma_f32_16x16x32_bf16 v[160:163], v[232:235], v[88:91], v[160:163]
    ds_read_b128 v[152:155], v13 offset:30720
    s_waitcnt lgkmcnt(15)
    v_mfma_f32_16x16x32_bf16 v[160:163], v[236:239], v[92:95], v[160:163]
    ds_read_b128 v[156:159], v13 offset:31744
    s_waitcnt vmcnt(2)
    s_barrier
    s_waitcnt lgkmcnt(15)
    v_mfma_f32_16x16x32_bf16 v[164:167], v[176:179], v[96:99], 0
    ds_read_b128 v[32:35], v13 offset:32768
    s_waitcnt lgkmcnt(15)
    v_mfma_f32_16x16x32_bf16 v[164:167], v[180:183], v[100:103], v[164:167]
    ds_read_b128 v[36:39], v13 offset:33792
    s_waitcnt lgkmcnt(15)
    v_mfma_f32_16x16x32_bf16 v[164:167], v[184:187], v[104:107], v[164:167]
    ds_read_b128 v[40:43], v13 offset:34816
    s_waitcnt lgkmcnt(15)
    v_mfma_f32_16x16x32_bf16 v[164:167], v[188:191], v[108:111], v[164:167]
    ds_read_b128 v[44:47], v13 offset:35840
    v_cvt_pk_bf16_f32 v160, v160, v161
    v_cvt_pk_bf16_f32 v161, v162, v163
    buffer_store_dwordx2 v[160:161], v14, s[16:19], s76 offen
    s_waitcnt lgkmcnt(15)
    v_mfma_f32_16x16x32_bf16 v[164:167], v[192:195], v[112:115], v[164:167]
    ds_read_b128 v[48:51], v13 offset:36864
    s_waitcnt lgkmcnt(15)
    v_mfma_f32_16x16x32_bf16 v[164:167], v[196:199], v[116:119], v[164:167]
    ds_read_b128 v[52:55], v13 offset:37888
    s_waitcnt lgkmcnt(15)
    v_mfma_f32_16x16x32_bf16 v[164:167], v[200:203], v[120:123], v[164:167]
    ds_read_b128 v[56:59], v13 offset:38912
    s_waitcnt lgkmcnt(15)
    v_mfma_f32_16x16x32_bf16 v[164:167], v[204:207], v[124:127], v[164:167]
    ds_read_b128 v[60:63], v13 offset:39936
    s_waitcnt lgkmcnt(15)
    v_mfma_f32_16x16x32_bf16 v[164:167], v[208:211], v[128:131], v[164:167]
    ds_read_b128 v[64:67], v13 offset:40960
    s_waitcnt lgkmcnt(15)
    v_mfma_f32_16x16x32_bf16 v[164:167], v[212:215], v[132:135], v[164:167]
    ds_read_b128 v[68:71], v13 offset:41984
    s_waitcnt lgkmcnt(15)
    v_mfma_f32_16x16x32_bf16 v[164:167], v[216:219], v[136:139], v[164:167]
    ds_read_b128 v[72:75], v13 offset:43008
    s_waitcnt lgkmcnt(15)
    v_mfma_f32_16x16x32_bf16 v[164:167], v[220:223], v[140:143], v[164:167]
    ds_read_b128 v[76:79], v13 offset:44032
    s_waitcnt lgkmcnt(15)
    v_mfma_f32_16x16x32_bf16 v[164:167], v[224:227], v[144:147], v[164:167]
    ds_read_b128 v[80:83], v13 offset:45056
    s_waitcnt lgkmcnt(15)
    v_mfma_f32_16x16x32_bf16 v[164:167], v[228:231], v[148:151], v[164:167]
    ds_read_b128 v[84:87], v13 offset:46080
    s_waitcnt lgkmcnt(15)
    v_mfma_f32_16x16x32_bf16 v[164:167], v[232:235], v[152:155], v[164:167]
    ds_read_b128 v[88:91], v13 offset:47104
    s_waitcnt lgkmcnt(15)
    v_mfma_f32_16x16x32_bf16 v[164:167], v[236:239], v[156:159], v[164:167]
    ds_read_b128 v[92:95], v13 offset:48128
    s_waitcnt vmcnt(1)
    s_barrier
    s_waitcnt lgkmcnt(15)
    v_mfma_f32_16x16x32_bf16 v[160:163], v[176:179], v[32:35], 0
    ds_read_b128 v[96:99], v13 offset:49152
    s_waitcnt lgkmcnt(15)
    v_mfma_f32_16x16x32_bf16 v[160:163], v[180:183], v[36:39], v[160:163]
    ds_read_b128 v[100:103], v13 offset:50176
    s_waitcnt lgkmcnt(15)
    v_mfma_f32_16x16x32_bf16 v[160:163], v[184:187], v[40:43], v[160:163]
    ds_read_b128 v[104:107], v13 offset:51200
    s_waitcnt lgkmcnt(15)
    v_mfma_f32_16x16x32_bf16 v[160:163], v[188:191], v[44:47], v[160:163]
    ds_read_b128 v[108:111], v13 offset:52224
    v_cvt_pk_bf16_f32 v164, v164, v165
    v_cvt_pk_bf16_f32 v165, v166, v167
    buffer_store_dwordx2 v[164:165], v14, s[16:19], s77 offen
    s_waitcnt lgkmcnt(15)
    v_mfma_f32_16x16x32_bf16 v[160:163], v[192:195], v[48:51], v[160:163]
    ds_read_b128 v[112:115], v13 offset:53248
    s_waitcnt lgkmcnt(15)
    v_mfma_f32_16x16x32_bf16 v[160:163], v[196:199], v[52:55], v[160:163]
    ds_read_b128 v[116:119], v13 offset:54272
    s_waitcnt lgkmcnt(15)
    v_mfma_f32_16x16x32_bf16 v[160:163], v[200:203], v[56:59], v[160:163]
    ds_read_b128 v[120:123], v13 offset:55296
    s_waitcnt lgkmcnt(15)
    v_mfma_f32_16x16x32_bf16 v[160:163], v[204:207], v[60:63], v[160:163]
    ds_read_b128 v[124:127], v13 offset:56320
    s_waitcnt lgkmcnt(15)
    v_mfma_f32_16x16x32_bf16 v[160:163], v[208:211], v[64:67], v[160:163]
    ds_read_b128 v[128:131], v13 offset:57344
    s_waitcnt lgkmcnt(15)
    v_mfma_f32_16x16x32_bf16 v[160:163], v[212:215], v[68:71], v[160:163]
    ds_read_b128 v[132:135], v13 offset:58368
    s_waitcnt lgkmcnt(15)
    v_mfma_f32_16x16x32_bf16 v[160:163], v[216:219], v[72:75], v[160:163]
    ds_read_b128 v[136:139], v13 offset:59392
    s_waitcnt lgkmcnt(15)
    v_mfma_f32_16x16x32_bf16 v[160:163], v[220:223], v[76:79], v[160:163]
    ds_read_b128 v[140:143], v13 offset:60416
    s_waitcnt lgkmcnt(15)
    v_mfma_f32_16x16x32_bf16 v[160:163], v[224:227], v[80:83], v[160:163]
    ds_read_b128 v[144:147], v13 offset:61440
    s_waitcnt lgkmcnt(15)
    v_mfma_f32_16x16x32_bf16 v[160:163], v[228:231], v[84:87], v[160:163]
    ds_read_b128 v[148:151], v13 offset:62464
    s_waitcnt lgkmcnt(15)
    v_mfma_f32_16x16x32_bf16 v[160:163], v[232:235], v[88:91], v[160:163]
    ds_read_b128 v[152:155], v13 offset:63488
    s_waitcnt lgkmcnt(15)
    v_mfma_f32_16x16x32_bf16 v[160:163], v[236:239], v[92:95], v[160:163]
    ds_read_b128 v[156:159], v13 offset:64512
    s_waitcnt lgkmcnt(15)
    v_mfma_f32_16x16x32_bf16 v[164:167], v[176:179], v[96:99], 0
    s_waitcnt lgkmcnt(14)
    v_mfma_f32_16x16x32_bf16 v[164:167], v[180:183], v[100:103], v[164:167]
    s_waitcnt lgkmcnt(13)
    v_mfma_f32_16x16x32_bf16 v[164:167], v[184:187], v[104:107], v[164:167]
    s_waitcnt lgkmcnt(12)
    v_mfma_f32_16x16x32_bf16 v[164:167], v[188:191], v[108:111], v[164:167]
    v_cvt_pk_bf16_f32 v160, v160, v161
    v_cvt_pk_bf16_f32 v161, v162, v163
    buffer_store_dwordx2 v[160:161], v14, s[16:19], s78 offen
    s_waitcnt lgkmcnt(11)
    v_mfma_f32_16x16x32_bf16 v[164:167], v[192:195], v[112:115], v[164:167]
    s_waitcnt lgkmcnt(10)
    v_mfma_f32_16x16x32_bf16 v[164:167], v[196:199], v[116:119], v[164:167]
    s_waitcnt lgkmcnt(9)
    v_mfma_f32_16x16x32_bf16 v[164:167], v[200:203], v[120:123], v[164:167]
    s_waitcnt lgkmcnt(8)
    v_mfma_f32_16x16x32_bf16 v[164:167], v[204:207], v[124:127], v[164:167]
    s_waitcnt lgkmcnt(7)
    v_mfma_f32_16x16x32_bf16 v[164:167], v[208:211], v[128:131], v[164:167]
    s_waitcnt lgkmcnt(6)
    v_mfma_f32_16x16x32_bf16 v[164:167], v[212:215], v[132:135], v[164:167]
    s_waitcnt lgkmcnt(5)
    v_mfma_f32_16x16x32_bf16 v[164:167], v[216:219], v[136:139], v[164:167]
    s_waitcnt lgkmcnt(4)
    v_mfma_f32_16x16x32_bf16 v[164:167], v[220:223], v[140:143], v[164:167]
    s_waitcnt lgkmcnt(3)
    v_mfma_f32_16x16x32_bf16 v[164:167], v[224:227], v[144:147], v[164:167]
    s_waitcnt lgkmcnt(2)
    v_mfma_f32_16x16x32_bf16 v[164:167], v[228:231], v[148:151], v[164:167]
    s_waitcnt lgkmcnt(1)
    v_mfma_f32_16x16x32_bf16 v[164:167], v[232:235], v[152:155], v[164:167]
    s_waitcnt lgkmcnt(0)
    v_mfma_f32_16x16x32_bf16 v[164:167], v[236:239], v[156:159], v[164:167]
    s_nop 7
    s_nop 7
    v_cvt_pk_bf16_f32 v164, v164, v165
    v_cvt_pk_bf16_f32 v165, v166, v167
    buffer_store_dwordx2 v[164:165], v14, s[16:19], s79 offen
    s_waitcnt lgkmcnt(0)
    s_branch K_END
PB_W7:
    ds_read_b32 v29, v31
    s_waitcnt lgkmcnt(0)
    v_cmp_ne_u32 vcc, 0, v29
    s_nop 4
    s_cbranch_vccnz FALLBACK
    s_waitcnt vmcnt(4)
    s_barrier
    s_waitcnt vmcnt(2)
    s_barrier
    s_waitcnt vmcnt(0)
    s_barrier
    s_branch K_END
P2_A:
    s_and_b32 s44, s2, 7
    s_lshl_b32 s44, s44, 15
    s_add_u32 s44, s44, 6291456
    s_mov_b32 s46, 0
    s_mov_b32 s48, s10
    s_and_b32 s49, s11, 0xffff
    s_mov_b32 s50, 401408
    s_mov_b32 s51, 0x00020000
    s_lshl_b32 s29, s27, 10
    v_add_u32 v2, s29, v11
    s_lshr_b32 s29, s27, 1
    s_lshl_b32 s29, s29, 10
    s_and_b32 s30, s27, 1
    s_lshl_b32 s30, s30, 3
    s_add_u32 s29, s29, s30
    s_add_u32 s29, s29, 8192
    v_add_u32 v3, s29, v11
    s_lshr_b32 s29, s27, 2
    s_lshl_b32 s29, s29, 10
    s_lshl_b32 s30, s38, 2
    s_add_u32 s29, s29, s30
    s_add_u32 s29, s29, 12288
    v_add_u32 v4, s29, v11
    v_mov_b32 v18, 127
    s_cmp_lt_u32 s27, 4
    s_cselect_b32 s45, s45, 14
    s_cmp_eq_u32 s96, 0
    s_cbranch_scc0 PA_FB
    s_cmp_lt_u32 s27, 4
    s_cbranch_scc1 PA_F1
    s_mov_b32 s43, 2
    s_cmp_eq_u32 s46, 0
    s_cbranch_scc1 WFT
WFR2:
    s_waitcnt vmcnt(0)
    s_cmp_eq_u32 s92, 0
    s_cbranch_scc1 SL9
    buffer_store_dwordx2 v[242:243], v9, s[20:23], 0 offen
    s_branch SD9
SL9:
    buffer_store_dwordx2 v[242:243], v9, s[20:23], 0 offen sc0 sc1
SD9:
PA_F1:
WR_h:
    s_cmp_lt_u32 s45, 8
    s_cbranch_scc0 WRD_h
    s_mul_i32 s29, s45, 7168
    s_mul_i32 s30, s45, 28672
    s_add_u32 s45, s45, 4
    s_add_u32 m0, s29, 0
    s_nop 0
    buffer_load_dwordx4 v224, s[48:51], s30 offen lds
    s_add_u32 m0, s29, 1024
    s_nop 0
    buffer_load_dwordx4 v225, s[48:51], s30 offen lds
    s_add_u32 m0, s29, 2048
    s_nop 0
    buffer_load_dwordx4 v226, s[48:51], s30 offen lds
    s_add_u32 m0, s29, 3072
    s_nop 0
    buffer_load_dwordx4 v227, s[48:51], s30 offen lds
    s_add_u32 m0, s29, 4096
    s_nop 0
    buffer_load_dwordx4 v228, s[48:51], s30 offen lds
    s_add_u32 m0, s29, 5120
    s_nop 0
    buffer_load_dwordx4 v229, s[48:51], s30 offen lds
    s_add_u32 m0, s29, 6144
    s_nop 0
    buffer_load_dwordx4 v230, s[48:51], s30 offen lds
    s_branch WR_h
WRD_h:
PA_FP:
    s_cmp_eq_u32 s92, 0
    s_cbranch_scc1 SL10
    buffer_load_dwordx2 v[20:21], v10, s[20:23], 0 offen sc1
    s_branch SD10
SL10:
    buffer_load_dwordx2 v[20:21], v10, s[20:23], 0 offen sc0 sc1
SD10:
    s_mov_b32 s43, 0
    s_cmp_eq_u32 s46, 0
    s_cbranch_scc1 WFT
WFR0:
    s_waitcnt vmcnt(0)
    ds_write_b32 v30, v18 offset:160
    v_xor_b32 v20, 0x7f4a7c10, v20
    v_xor_b32 v21, 0x9e3779b9, v21
    v_sub_co_u32 v20, vcc, v20, v240
    s_nop 1
    v_subb_co_u32 v21, vcc, v21, v241, vcc
    v_lshrrev_b32 v20, 24, v20
    v_or_b32 v20, v20, v21
    v_cmp_ne_u32 vcc, 0, v20
    s_nop 4
    s_cbranch_vccz PA_FOK
    s_add_u32 s93, s93, 1
    s_cmp_lt_u32 s93, 4000
    s_cbranch_scc1 PA_FP
    s_branch PA_FAIL
PA_FOK:
    s_cmp_eq_u32 s92, 0
    s_cbranch_scc1 SL11
    buffer_load_dwordx4 v[32:35], v15, s[20:23], s72 offen offset:0 sc1
    buffer_load_dwordx4 v[36:39], v15, s[20:23], s72 offen offset:1024 sc1
    buffer_load_dwordx4 v[40:43], v15, s[20:23], s73 offen offset:0 sc1
    buffer_load_dwordx4 v[44:47], v15, s[20:23], s73 offen offset:1024 sc1
    buffer_load_dwordx4 v[48:51], v15, s[20:23], s74 offen offset:0 sc1
    buffer_load_dwordx4 v[52:55], v15, s[20:23], s74 offen offset:1024 sc1
    buffer_load_dwordx4 v[56:59], v15, s[20:23], s75 offen offset:0 sc1
    buffer_load_dwordx4 v[60:63], v15, s[20:23], s75 offen offset:1024 sc1
    s_branch SD11
SL11:
    buffer_load_dwordx4 v[32:35], v15, s[20:23], s72 offen offset:0 sc0 sc1
    buffer_load_dwordx4 v[36:39], v15, s[20:23], s72 offen offset:1024 sc0 sc1
    buffer_load_dwordx4 v[40:43], v15, s[20:23], s73 offen offset:0 sc0 sc1
    buffer_load_dwordx4 v[44:47], v15, s[20:23], s73 offen offset:1024 sc0 sc1
    buffer_load_dwordx4 v[48:51], v15, s[20:23], s74 offen offset:0 sc0 sc1
    buffer_load_dwordx4 v[52:55], v15, s[20:23], s74 offen offset:1024 sc0 sc1
    buffer_load_dwordx4 v[56:59], v15, s[20:23], s75 offen offset:0 sc0 sc1
    buffer_load_dwordx4 v[60:63], v15, s[20:23], s75 offen offset:1024 sc0 sc1
SD11:
    s_mov_b64 s[52:53], -1
    s_mov_b64 s[54:55], -1
    s_mov_b64 s[56:57], -1
    s_mov_b64 s[58:59], -1
PA_KL:
    s_cmp_eq_u32 s92, 0
    s_cbranch_scc1 SL12
    s_mov_b64 exec, s[52:53]
    buffer_load_dwordx4 v[64:67], v12, s[20:23], s44 offen offset:0 sc1
    s_mov_b64 exec, s[54:55]
    buffer_load_dwordx4 v[68:71], v12, s[20:23], s44 offen offset:1024 sc1
    s_mov_b64 exec, s[56:57]
    buffer_load_dwordx4 v[72:75], v12, s[20:23], s44 offen offset:2048 sc1
    s_mov_b64 exec, s[58:59]
    buffer_load_dwordx4 v[76:79], v12, s[20:23], s44 offen offset:3072 sc1
    s_branch SD12
SL12:
    s_mov_b64 exec, s[52:53]
    buffer_load_dwordx4 v[64:67], v12, s[20:23], s44 offen offset:0 sc0 sc1
    s_mov_b64 exec, s[54:55]
    buffer_load_dwordx4 v[68:71], v12, s[20:23], s44 offen offset:1024 sc0 sc1
    s_mov_b64 exec, s[56:57]
    buffer_load_dwordx4 v[72:75], v12, s[20:23], s44 offen offset:2048 sc0 sc1
    s_mov_b64 exec, s[58:59]
    buffer_load_dwordx4 v[76:79], v12, s[20:23], s44 offen offset:3072 sc0 sc1
SD12:
    s_mov_b64 exec, -1
    ds_write_b32 v30, v18 offset:192
    s_mov_b32 s47, 0
    s_mov_b32 s42, 0
    s_cmp_lt_u32 s45, 14
    s_cbranch_scc1 WOT
WOR0:
    s_mov_b32 s43, 1
    s_cmp_eq_u32 s46, 0
    s_cbranch_scc1 WFT
WFR1:
    s_waitcnt vmcnt(14)
    s_cmp_eq_u32 s47, 2
    s_cbranch_scc1 PA_KC
    s_waitcnt vmcnt(7)
    s_cmp_eq_u32 s47, 1
    s_cbranch_scc1 PA_KC
    s_waitcnt vmcnt(0)
PA_KC:
    v_max3_u32 v80, v64, v65, v66
    v_max3_u32 v81, v68, v69, v70
    v_max3_u32 v82, v72, v73, v74
    v_max3_u32 v83, v76, v77, v78
    v_max_u32 v80, v80, v67
    v_max_u32 v81, v81, v71
    v_max_u32 v82, v82, v75
    v_max_u32 v83, v83, v79
    v_cmp_eq_u32 s[52:53], -1, v80
    v_cmp_eq_u32 s[54:55], -1, v81
    v_cmp_eq_u32 s[56:57], -1, v82
    v_cmp_eq_u32 s[58:59], -1, v83
    s_nop 4
    s_or_b64 s[60:61], s[52:53], s[54:55]
    s_or_b64 s[62:63], s[56:57], s[58:59]
    s_or_b64 s[60:61], s[60:61], s[62:63]
    s_cbranch_scc0 PA_GO
    s_add_u32 s93, s93, 1
    s_cmp_lt_u32 s93, 4000
    s_cbranch_scc1 PA_KL
PA_FAIL:
    ds_write_b32 v30, v18 offset:192
    s_mov_b32 s89, 1
    s_branch PA_ST
WOT:
    ds_read_b32 v1, v31 offset:192
    s_waitcnt lgkmcnt(0)
    v_cmp_eq_u32 vcc, 0, v1
    s_nop 4
    s_cbranch_vccnz WOX
WOL:
    s_mul_i32 s29, s45, 7168
    s_mul_i32 s30, s45, 28672
    s_add_u32 s45, s45, 4
    s_add_u32 m0, s29, 0
    s_nop 0
    buffer_load_dwordx4 v224, s[48:51], s30 offen lds
    s_add_u32 m0, s29, 1024
    s_nop 0
    buffer_load_dwordx4 v225, s[48:51], s30 offen lds
    s_add_u32 m0, s29, 2048
    s_nop 0
    buffer_load_dwordx4 v226, s[48:51], s30 offen lds
    s_add_u32 m0, s29, 3072
    s_nop 0
    buffer_load_dwordx4 v227, s[48:51], s30 offen lds
    s_add_u32 m0, s29, 4096
    s_nop 0
    buffer_load_dwordx4 v228, s[48:51], s30 offen lds
    s_add_u32 m0, s29, 5120
    s_nop 0
    buffer_load_dwordx4 v229, s[48:51], s30 offen lds
    s_add_u32 m0, s29, 6144
    s_nop 0
    buffer_load_dwordx4 v230, s[48:51], s30 offen lds
    s_add_u32 s47, s47, 1
    s_cmp_lt_u32 s45, 14
    s_cbranch_scc1 WOL
WOX:
    s_cmp_eq_u32 s42, 0
    s_cbranch_scc1 WOR0
    s_cmp_eq_u32 s42, 1
    s_cbranch_scc1 WOR1
    s_branch WOR2
WFT:
    ds_read_b32 v1, v31 offset:160
    s_waitcnt lgkmcnt(0)
    v_cmp_eq_u32 vcc, 0, v1
    s_nop 4
    s_cbranch_vccnz WFX
    ds_read_b64_tr_b16 v[176:177], v232 offset:0
    ds_read_b64_tr_b16 v[178:179], v232 offset:6272
    ds_read_b64_tr_b16 v[180:181], v232 offset:12544
    ds_read_b64_tr_b16 v[182:183], v232 offset:18816
    ds_read_b64_tr_b16 v[184:185], v232 offset:25088
    ds_read_b64_tr_b16 v[186:187], v232 offset:31360
    ds_read_b64_tr_b16 v[188:189], v232 offset:37632
    ds_read_b64_tr_b16 v[190:191], v232 offset:43904
    ds_read_b64_tr_b16 v[192:193], v233 offset:0
    ds_read_b64_tr_b16 v[194:195], v233 offset:12544
    ds_read_b64_tr_b16 v[196:197], v233 offset:25088
    ds_read_b64_tr_b16 v[198:199], v233 offset:37632
    ds_read_b64_tr_b16 v[200:201], v234 offset:0
    ds_read_b64_tr_b16 v[202:203], v234 offset:25088
    s_mov_b32 s46, 1
WFX:
    s_cmp_eq_u32 s43, 0
    s_cbranch_scc1 WFR0
    s_cmp_eq_u32 s43, 1
    s_cbranch_scc1 WFR1
    s_cmp_eq_u32 s43, 2
    s_cbranch_scc1 WFR2
    s_branch PA_W1
PA_FB:
WR_f:
    s_cmp_lt_u32 s45, 14
    s_cbranch_scc0 WRD_f
    s_mul_i32 s29, s45, 7168
    s_mul_i32 s30, s45, 28672
    s_add_u32 s45, s45, 4
    s_add_u32 m0, s29, 0
    s_nop 0
    buffer_load_dwordx4 v224, s[48:51], s30 offen lds
    s_add_u32 m0, s29, 1024
    s_nop 0
    buffer_load_dwordx4 v225, s[48:51], s30 offen lds
    s_add_u32 m0, s29, 2048
    s_nop 0
    buffer_load_dwordx4 v226, s[48:51], s30 offen lds
    s_add_u32 m0, s29, 3072
    s_nop 0
    buffer_load_dwordx4 v227, s[48:51], s30 offen lds
    s_add_u32 m0, s29, 4096
    s_nop 0
    buffer_load_dwordx4 v228, s[48:51], s30 offen lds
    s_add_u32 m0, s29, 5120
    s_nop 0
    buffer_load_dwordx4 v229, s[48:51], s30 offen lds
    s_add_u32 m0, s29, 6144
    s_nop 0
    buffer_load_dwordx4 v230, s[48:51], s30 offen lds
    s_branch WR_f
WRD_f:
    s_cmp_eq_u32 s92, 0
    s_cbranch_scc1 SL13
    buffer_load_dwordx4 v[32:35], v15, s[20:23], s72 offen offset:0 sc1
    buffer_load_dwordx4 v[36:39], v15, s[20:23], s72 offen offset:1024 sc1
    buffer_load_dwordx4 v[40:43], v15, s[20:23], s73 offen offset:0 sc1
    buffer_load_dwordx4 v[44:47], v15, s[20:23], s73 offen offset:1024 sc1
    buffer_load_dwordx4 v[48:51], v15, s[20:23], s74 offen offset:0 sc1
    buffer_load_dwordx4 v[52:55], v15, s[20:23], s74 offen offset:1024 sc1
    buffer_load_dwordx4 v[56:59], v15, s[20:23], s75 offen offset:0 sc1
    buffer_load_dwordx4 v[60:63], v15, s[20:23], s75 offen offset:1024 sc1
    s_branch SD13
SL13:
    buffer_load_dwordx4 v[32:35], v15, s[20:23], s72 offen offset:0 sc0 sc1
    buffer_load_dwordx4 v[36:39], v15, s[20:23], s72 offen offset:1024 sc0 sc1
    buffer_load_dwordx4 v[40:43], v15, s[20:23], s73 offen offset:0 sc0 sc1
    buffer_load_dwordx4 v[44:47], v15, s[20:23], s73 offen offset:1024 sc0 sc1
    buffer_load_dwordx4 v[48:51], v15, s[20:23], s74 offen offset:0 sc0 sc1
    buffer_load_dwordx4 v[52:55], v15, s[20:23], s74 offen offset:1024 sc0 sc1
    buffer_load_dwordx4 v[56:59], v15, s[20:23], s75 offen offset:0 sc0 sc1
    buffer_load_dwordx4 v[60:63], v15, s[20:23], s75 offen offset:1024 sc0 sc1
SD13:
    v_lshrrev_b32 v7, 2, v16
    v_and_b32 v6, 3, v16
    v_mul_u32_u24 v7, 3, v7
    v_add_u32 v7, v7, v6
    v_add_u32 v7, 64, v7
    v_cmp_eq_u32 vcc, 3, v6
    v_mov_b32 v6, 76
    s_nop 0
    v_cndmask_b32 v7, v7, v6, vcc
    v_lshl_add_u32 v7, v17, 4, v7
    v_lshlrev_b32 v7, 4, v7
    s_lshr_b32 s35, s95, 1
    s_lshl_b32 s35, s35, 17
    s_add_u32 s35, s35, 16777216
    s_lshl_b32 s29, s27, 13
    s_add_u32 s35, s35, s29
    s_add_u32 s36, s35, 0
    buffer_load_dwordx4 v[80:83], v13, s[20:23], s36 offen offset:0 sc0 sc1
    buffer_load_dwordx4 v[84:87], v13, s[20:23], s36 offen offset:2048 sc0 sc1
    buffer_load_dwordx4 v[88:91], v7, s[20:23], s36 offen offset:0 sc0 sc1
    buffer_load_dwordx4 v[92:95], v7, s[20:23], s36 offen offset:2048 sc0 sc1
    s_add_u32 s36, s35, 4096
    buffer_load_dwordx4 v[96:99], v13, s[20:23], s36 offen offset:0 sc0 sc1
    buffer_load_dwordx4 v[100:103], v13, s[20:23], s36 offen offset:2048 sc0 sc1
    buffer_load_dwordx4 v[104:107], v7, s[20:23], s36 offen offset:0 sc0 sc1
    buffer_load_dwordx4 v[108:111], v7, s[20:23], s36 offen offset:2048 sc0 sc1
    s_add_u32 s36, s35, 65536
    buffer_load_dwordx4 v[112:115], v13, s[20:23], s36 offen offset:0 sc0 sc1
    buffer_load_dwordx4 v[116:119], v13, s[20:23], s36 offen offset:2048 sc0 sc1
    buffer_load_dwordx4 v[120:123], v7, s[20:23], s36 offen offset:0 sc0 sc1
    buffer_load_dwordx4 v[124:127], v7, s[20:23], s36 offen offset:2048 sc0 sc1
    s_add_u32 s36, s35, 69632
    buffer_load_dwordx4 v[128:131], v13, s[20:23], s36 offen offset:0 sc0 sc1
    buffer_load_dwordx4 v[132:135], v13, s[20:23], s36 offen offset:2048 sc0 sc1
    buffer_load_dwordx4 v[136:139], v7, s[20:23], s36 offen offset:0 sc0 sc1
    buffer_load_dwordx4 v[140:143], v7, s[20:23], s36 offen offset:2048 sc0 sc1
    s_waitcnt vmcnt(0)
    ds_write_b32 v30, v18 offset:160
    v_pk_add_f32 v[80:81], v[80:81], v[112:113]
    v_pk_add_f32 v[82:83], v[82:83], v[114:115]
    v_pk_add_f32 v[84:85], v[84:85], v[116:117]
    v_pk_add_f32 v[86:87], v[86:87], v[118:119]
    v_pk_add_f32 v[88:89], v[88:89], v[120:121]
    v_pk_add_f32 v[90:91], v[90:91], v[122:123]
    v_pk_add_f32 v[92:93], v[92:93], v[124:125]
    v_pk_add_f32 v[94:95], v[94:95], v[126:127]
    v_pk_add_f32 v[96:97], v[96:97], v[128:129]
    v_pk_add_f32 v[98:99], v[98:99], v[130:131]
    v_pk_add_f32 v[100:101], v[100:101], v[132:133]
    v_pk_add_f32 v[102:103], v[102:103], v[134:135]
    v_pk_add_f32 v[104:105], v[104:105], v[136:137]
    v_pk_add_f32 v[106:107], v[106:107], v[138:139]
    v_pk_add_f32 v[108:109], v[108:109], v[140:141]
    v_pk_add_f32 v[110:111], v[110:111], v[142:143]
    v_cvt_pk_bf16_f32 v64, v80, v81
    v_cvt_pk_bf16_f32 v65, v82, v83
    v_cvt_pk_bf16_f32 v66, v84, v85
    v_cvt_pk_bf16_f32 v67, v86, v87
    v_cvt_pk_bf16_f32 v68, v88, v89
    v_cvt_pk_bf16_f32 v69, v90, v91
    v_cvt_pk_bf16_f32 v70, v92, v93
    v_cvt_pk_bf16_f32 v71, v94, v95
    v_cvt_pk_bf16_f32 v72, v96, v97
    v_cvt_pk_bf16_f32 v73, v98, v99
    v_cvt_pk_bf16_f32 v74, v100, v101
    v_cvt_pk_bf16_f32 v75, v102, v103
    v_cvt_pk_bf16_f32 v76, v104, v105
    v_cvt_pk_bf16_f32 v77, v106, v107
    v_cvt_pk_bf16_f32 v78, v108, v109
    v_cvt_pk_bf16_f32 v79, v110, v111
    v_cndmask_b32 v66, v66, 0, s[66:67]
    v_cndmask_b32 v67, v67, 0, s[66:67]
    v_cndmask_b32 v70, v70, 0, s[66:67]
    v_cndmask_b32 v71, v71, 0, s[66:67]
    v_cndmask_b32 v74, v74, 0, s[66:67]
    v_cndmask_b32 v75, v75, 0, s[66:67]
    v_cndmask_b32 v78, v78, 0, s[66:67]
    v_cndmask_b32 v79, v79, 0, s[66:67]
    s_nop 1
PA_GO:
    s_mov_b32 s42, 1
    s_cmp_lt_u32 s45, 14
    s_cbranch_scc1 WOT
WOR1:
    v_mfma_f32_16x16x32_bf16 v[80:83], v[64:67], v[32:35], 0
    v_mfma_f32_16x16x32_bf16 v[84:87], v[68:71], v[32:35], v[248:251]
    v_mfma_f32_16x16x32_bf16 v[88:91], v[72:75], v[36:39], 0
    v_mfma_f32_16x16x32_bf16 v[92:95], v[76:79], v[36:39], v[248:251]
    v_mfma_f32_16x16x32_bf16 v[96:99], v[64:67], v[40:43], 0
    v_mfma_f32_16x16x32_bf16 v[100:103], v[68:71], v[40:43], v[248:251]
    v_rcp_f32 v87, v87
    s_nop 0
    v_pk_mul_f32 v[80:81], v[80:81], v[86:87] op_sel:[0,1] op_sel_hi:[1,1]
    v_pk_mul_f32 v[82:83], v[82:83], v[86:87] op_sel:[0,1] op_sel_hi:[1,1]
    v_pk_mul_f32 v[84:85], v[84:85], v[86:87] op_sel:[0,1] op_sel_hi:[1,1]
    v_mul_f32 v86, v86, v87
    v_cvt_pk_bf16_f32 v32, v80, v81
    v_cvt_pk_bf16_f32 v33, v82, v83
    v_cvt_pk_bf16_f32 v36, v84, v85
    s_mov_b32 s43, 3
PA_W1:
    s_cmp_eq_u32 s46, 0
    s_cbranch_scc1 WFT
    v_mfma_f32_16x16x32_bf16 v[104:107], v[72:75], v[44:47], 0
    v_mfma_f32_16x16x32_bf16 v[108:111], v[76:79], v[44:47], v[248:251]
    v_rcp_f32 v95, v95
    s_nop 0
    v_pk_mul_f32 v[88:89], v[88:89], v[94:95] op_sel:[0,1] op_sel_hi:[1,1]
    v_pk_mul_f32 v[90:91], v[90:91], v[94:95] op_sel:[0,1] op_sel_hi:[1,1]
    v_pk_mul_f32 v[92:93], v[92:93], v[94:95] op_sel:[0,1] op_sel_hi:[1,1]
    v_mul_f32 v94, v94, v95
    v_cvt_pk_bf16_f32 v34, v88, v89
    v_cvt_pk_bf16_f32 v35, v90, v91
    v_cvt_pk_bf16_f32 v37, v86, v92
    v_cvt_pk_bf16_f32 v38, v93, v94
    ds_write_b128 v2, v[32:35] offset:0
    ds_write_b64 v3, v[36:37] offset:0
    ds_write_b32 v4, v38 offset:0
    v_mfma_f32_16x16x32_bf16 v[80:83], v[64:67], v[48:51], 0
    v_mfma_f32_16x16x32_bf16 v[84:87], v[68:71], v[48:51], v[248:251]
    v_rcp_f32 v103, v103
    s_nop 0
    v_pk_mul_f32 v[96:97], v[96:97], v[102:103] op_sel:[0,1] op_sel_hi:[1,1]
    v_pk_mul_f32 v[98:99], v[98:99], v[102:103] op_sel:[0,1] op_sel_hi:[1,1]
    v_pk_mul_f32 v[100:101], v[100:101], v[102:103] op_sel:[0,1] op_sel_hi:[1,1]
    v_mul_f32 v102, v102, v103
    v_cvt_pk_bf16_f32 v40, v96, v97
    v_cvt_pk_bf16_f32 v41, v98, v99
    v_cvt_pk_bf16_f32 v44, v100, v101
    v_mfma_f32_16x16x32_bf16 v[88:91], v[72:75], v[52:55], 0
    v_mfma_f32_16x16x32_bf16 v[92:95], v[76:79], v[52:55], v[248:251]
    v_rcp_f32 v111, v111
    s_nop 0
    v_pk_mul_f32 v[104:105], v[104:105], v[110:111] op_sel:[0,1] op_sel_hi:[1,1]
    v_pk_mul_f32 v[106:107], v[106:107], v[110:111] op_sel:[0,1] op_sel_hi:[1,1]
    v_pk_mul_f32 v[108:109], v[108:109], v[110:111] op_sel:[0,1] op_sel_hi:[1,1]
    v_mul_f32 v110, v110, v111
    v_cvt_pk_bf16_f32 v42, v104, v105
    v_cvt_pk_bf16_f32 v43, v106, v107
    v_cvt_pk_bf16_f32 v45, v102, v108
    v_cvt_pk_bf16_f32 v46, v109, v110
    ds_write_b128 v2, v[40:43] offset:14336
    ds_write_b64 v3, v[44:45] offset:14336
    ds_write_b32 v4, v46 offset:14336
    v_mfma_f32_16x16x32_bf16 v[96:99], v[64:67], v[56:59], 0
    v_mfma_f32_16x16x32_bf16 v[100:103], v[68:71], v[56:59], v[248:251]
    v_rcp_f32 v87, v87
    s_nop 0
    v_pk_mul_f32 v[80:81], v[80:81], v[86:87] op_sel:[0,1] op_sel_hi:[1,1]
    v_pk_mul_f32 v[82:83], v[82:83], v[86:87] op_sel:[0,1] op_sel_hi:[1,1]
    v_pk_mul_f32 v[84:85], v[84:85], v[86:87] op_sel:[0,1] op_sel_hi:[1,1]
    v_mul_f32 v86, v86, v87
    v_cvt_pk_bf16_f32 v48, v80, v81
    v_cvt_pk_bf16_f32 v49, v82, v83
    v_cvt_pk_bf16_f32 v52, v84, v85
    v_mfma_f32_16x16x32_bf16 v[104:107], v[72:75], v[60:63], 0
    v_mfma_f32_16x16x32_bf16 v[108:111], v[76:79], v[60:63], v[248:251]
    v_rcp_f32 v95, v95
    s_nop 0
    v_pk_mul_f32 v[88:89], v[88:89], v[94:95] op_sel:[0,1] op_sel_hi:[1,1]
    v_pk_mul_f32 v[90:91], v[90:91], v[94:95] op_sel:[0,1] op_sel_hi:[1,1]
    v_pk_mul_f32 v[92:93], v[92:93], v[94:95] op_sel:[0,1] op_sel_hi:[1,1]
    v_mul_f32 v94, v94, v95
    v_cvt_pk_bf16_f32 v50, v88, v89
    v_cvt_pk_bf16_f32 v51, v90, v91
    v_cvt_pk_bf16_f32 v53, v86, v92
    v_cvt_pk_bf16_f32 v54, v93, v94
    ds_write_b128 v2, v[48:51] offset:28672
    ds_write_b64 v3, v[52:53] offset:28672
    ds_write_b32 v4, v54 offset:28672
    s_nop 7
    v_rcp_f32 v103, v103
    s_nop 0
    v_pk_mul_f32 v[96:97], v[96:97], v[102:103] op_sel:[0,1] op_sel_hi:[1,1]
    v_pk_mul_f32 v[98:99], v[98:99], v[102:103] op_sel:[0,1] op_sel_hi:[1,1]
    v_pk_mul_f32 v[100:101], v[100:101], v[102:103] op_sel:[0,1] op_sel_hi:[1,1]
    v_mul_f32 v102, v102, v103
    v_cvt_pk_bf16_f32 v56, v96, v97
    v_cvt_pk_bf16_f32 v57, v98, v99
    v_cvt_pk_bf16_f32 v60, v100, v101
    s_nop 7
    v_rcp_f32 v111, v111
    s_nop 0
    v_pk_mul_f32 v[104:105], v[104:105], v[110:111] op_sel:[0,1] op_sel_hi:[1,1]
    v_pk_mul_f32 v[106:107], v[106:107], v[110:111] op_sel:[0,1] op_sel_hi:[1,1]
    v_pk_mul_f32 v[108:109], v[108:109], v[110:111] op_sel:[0,1] op_sel_hi:[1,1]
    v_mul_f32 v110, v110, v111
    v_cvt_pk_bf16_f32 v58, v104, v105
    v_cvt_pk_bf16_f32 v59, v106, v107
    v_cvt_pk_bf16_f32 v61, v102, v108
    v_cvt_pk_bf16_f32 v62, v109, v110
    ds_write_b128 v2, v[56:59] offset:43008
    ds_write_b64 v3, v[60:61] offset:43008
    ds_write_b32 v4, v62 offset:43008
PA_ST:
    s_mov_b32 s42, 2
WOR2:
    s_cmp_lt_u32 s45, 14
    s_cbranch_scc1 WOT
    s_cmp_eq_u32 s27, 7
    s_cselect_b32 s29, 127, 0
    v_mov_b32 v29, s89
    v_mov_b32 v28, s29
    ds_write2_b32 v30, v29, v28 offset0:0 offset1:56
    s_waitcnt vmcnt(0) lgkmcnt(0)
    s_barrier
    s_cmp_eq_u32 s27, 7
    s_cbranch_scc1 PA_W7
    ds_read_b32 v29, v31
    ds_read_b128 v[32:35], v11 offset:0
    ds_read_b128 v[36:39], v11 offset:1024
    ds_read_b128 v[40:43], v11 offset:2048
    ds_read_b128 v[44:47], v11 offset:3072
    ds_read_b128 v[48:51], v11 offset:8192
    ds_read_b128 v[52:55], v11 offset:9216
    ds_read_b128 v[56:59], v11 offset:12288
    s_waitcnt lgkmcnt(7)
    v_cmp_ne_u32 vcc, 0, v29
    s_nop 4
    s_cbranch_vccnz FALLBACK
    s_waitcnt lgkmcnt(6)
    v_mfma_f32_16x16x32_bf16 v[160:163], v[176:179], v[32:35], 0
    ds_read_b128 v[96:99], v11 offset:14336
    s_waitcnt lgkmcnt(6)
    v_mfma_f32_16x16x32_bf16 v[160:163], v[180:183], v[36:39], v[160:163]
    ds_read_b128 v[100:103], v11 offset:15360
    s_waitcnt lgkmcnt(6)
    v_mfma_f32_16x16x32_bf16 v[160:163], v[184:187], v[40:43], v[160:163]
    ds_read_b128 v[104:107], v11 offset:16384
    s_waitcnt lgkmcnt(6)
    v_mfma_f32_16x16x32_bf16 v[160:163], v[188:191], v[44:47], v[160:163]
    ds_read_b128 v[108:111], v11 offset:17408
    s_waitcnt lgkmcnt(6)
    v_mfma_f32_16x16x32_bf16 v[160:163], v[192:195], v[48:51], v[160:163]
    ds_read_b128 v[112:115], v11 offset:22528
    s_waitcnt lgkmcnt(6)
    v_mfma_f32_16x16x32_bf16 v[160:163], v[196:199], v[52:55], v[160:163]
    ds_read_b128 v[116:119], v11 offset:23552
    s_waitcnt lgkmcnt(6)
    v_mfma_f32_16x16x32_bf16 v[160:163], v[200:203], v[56:59], v[160:163]
    ds_read_b128 v[120:123], v11 offset:26624
    s_waitcnt lgkmcnt(6)
    v_mfma_f32_16x16x32_bf16 v[164:167], v[176:179], v[96:99], 0
    ds_read_b128 v[32:35], v11 offset:28672
    ds_read_b64_tr_b16 v[204:205], v235 offset:0
    s_waitcnt lgkmcnt(7)
    v_mfma_f32_16x16x32_bf16 v[164:167], v[180:183], v[100:103], v[164:167]
    ds_read_b128 v[36:39], v11 offset:29696
    ds_read_b64_tr_b16 v[206:207], v235 offset:6272
    s_waitcnt lgkmcnt(8)
    v_mfma_f32_16x16x32_bf16 v[164:167], v[184:187], v[104:107], v[164:167]
    ds_read_b128 v[40:43], v11 offset:30720
    ds_read_b64_tr_b16 v[208:209], v235 offset:12544
    s_waitcnt lgkmcnt(9)
    v_mfma_f32_16x16x32_bf16 v[164:167], v[188:191], v[108:111], v[164:167]
    ds_read_b128 v[44:47], v11 offset:31744
    ds_read_b64_tr_b16 v[210:211], v235 offset:18816
    s_waitcnt lgkmcnt(10)
    v_mfma_f32_16x16x32_bf16 v[164:167], v[192:195], v[112:115], v[164:167]
    ds_read_b128 v[48:51], v11 offset:36864
    ds_read_b64_tr_b16 v[212:213], v235 offset:25088
    s_waitcnt lgkmcnt(11)
    v_mfma_f32_16x16x32_bf16 v[164:167], v[196:199], v[116:119], v[164:167]
    ds_read_b128 v[52:55], v11 offset:37888
    ds_read_b64_tr_b16 v[214:215], v235 offset:31360
    s_waitcnt lgkmcnt(12)
    v_mfma_f32_16x16x32_bf16 v[164:167], v[200:203], v[120:123], v[164:167]
    ds_read_b128 v[56:59], v11 offset:40960
    ds_read_b64_tr_b16 v[216:217], v235 offset:37632
    s_waitcnt lgkmcnt(13)
    v_mfma_f32_16x16x32_bf16 v[168:171], v[176:179], v[32:35], 0
    ds_read_b128 v[96:99], v11 offset:43008
    ds_read_b64_tr_b16 v[218:219], v235 offset:43904
    s_waitcnt lgkmcnt(13)
    v_mfma_f32_16x16x32_bf16 v[168:171], v[180:183], v[36:39], v[168:171]
    ds_read_b128 v[100:103], v11 offset:44032
    ds_read_b64_tr_b16 v[220:221], v236 offset:0
    s_waitcnt lgkmcnt(13)
    v_mfma_f32_16x16x32_bf16 v[168:171], v[184:187], v[40:43], v[168:171]
    ds_read_b128 v[104:107], v11 offset:45056
    ds_read_b64_tr_b16 v[222:223], v236 offset:12544
    s_waitcnt lgkmcnt(13)
    v_mfma_f32_16x16x32_bf16 v[168:171], v[188:191], v[44:47], v[168:171]
    ds_read_b128 v[108:111], v11 offset:46080
    ds_read_b64_tr_b16 v[224:225], v236 offset:25088
    s_waitcnt lgkmcnt(13)
    v_mfma_f32_16x16x32_bf16 v[168:171], v[192:195], v[48:51], v[168:171]
    ds_read_b128 v[112:115], v11 offset:51200
    ds_read_b64_tr_b16 v[226:227], v236 offset:37632
    s_waitcnt lgkmcnt(13)
    v_mfma_f32_16x16x32_bf16 v[168:171], v[196:199], v[52:55], v[168:171]
    ds_read_b128 v[116:119], v11 offset:52224
    ds_read_b64_tr_b16 v[228:229], v237 offset:0
    s_waitcnt lgkmcnt(13)
    v_mfma_f32_16x16x32_bf16 v[168:171], v[200:203], v[56:59], v[168:171]
    ds_read_b128 v[120:123], v11 offset:55296
    ds_read_b64_tr_b16 v[230:231], v237 offset:25088
    s_waitcnt lgkmcnt(13)
    v_mfma_f32_16x16x32_bf16 v[172:175], v[176:179], v[96:99], 0
    ds_read_b128 v[32:35], v11 offset:4096
    s_waitcnt lgkmcnt(12)
    v_mfma_f32_16x16x32_bf16 v[172:175], v[180:183], v[100:103], v[172:175]
    ds_read_b128 v[36:39], v11 offset:5120
    s_waitcnt lgkmcnt(11)
    v_mfma_f32_16x16x32_bf16 v[172:175], v[184:187], v[104:107], v[172:175]
    ds_read_b128 v[40:43], v11 offset:6144
    s_waitcnt lgkmcnt(10)
    v_mfma_f32_16x16x32_bf16 v[172:175], v[188:191], v[108:111], v[172:175]
    ds_read_b128 v[44:47], v11 offset:7168
    s_waitcnt lgkmcnt(9)
    v_mfma_f32_16x16x32_bf16 v[172:175], v[192:195], v[112:115], v[172:175]
    ds_read_b128 v[48:51], v11 offset:10240
    s_waitcnt lgkmcnt(8)
    v_mfma_f32_16x16x32_bf16 v[172:175], v[196:199], v[116:119], v[172:175]
    ds_read_b128 v[52:55], v11 offset:11264
    s_waitcnt lgkmcnt(7)
    v_mfma_f32_16x16x32_bf16 v[172:175], v[200:203], v[120:123], v[172:175]
    ds_read_b128 v[56:59], v11 offset:13312
    s_waitcnt lgkmcnt(6)
    v_mfma_f32_16x16x32_bf16 v[160:163], v[204:207], v[32:35], v[160:163]
    ds_read_b128 v[96:99], v11 offset:18432
    s_waitcnt lgkmcnt(6)
    v_mfma_f32_16x16x32_bf16 v[160:163], v[208:211], v[36:39], v[160:163]
    ds_read_b128 v[100:103], v11 offset:19456
    s_waitcnt lgkmcnt(6)
    v_mfma_f32_16x16x32_bf16 v[160:163], v[212:215], v[40:43], v[160:163]
    ds_read_b128 v[104:107], v11 offset:20480
    s_waitcnt lgkmcnt(6)
    v_mfma_f32_16x16x32_bf16 v[160:163], v[216:219], v[44:47], v[160:163]
    ds_read_b128 v[108:111], v11 offset:21504
    s_waitcnt lgkmcnt(6)
    v_mfma_f32_16x16x32_bf16 v[160:163], v[220:223], v[48:51], v[160:163]
    ds_read_b128 v[112:115], v11 offset:24576
    s_waitcnt lgkmcnt(6)
    v_mfma_f32_16x16x32_bf16 v[160:163], v[224:227], v[52:55], v[160:163]
    ds_read_b128 v[116:119], v11 offset:25600
    s_waitcnt lgkmcnt(6)
    v_mfma_f32_16x16x32_bf16 v[160:163], v[228:231], v[56:59], v[160:163]
    ds_read_b128 v[120:123], v11 offset:27648
    s_waitcnt lgkmcnt(6)
    v_mfma_f32_16x16x32_bf16 v[164:167], v[204:207], v[96:99], v[164:167]
    ds_read_b128 v[32:35], v11 offset:32768
    s_waitcnt lgkmcnt(6)
    v_mfma_f32_16x16x32_bf16 v[164:167], v[208:211], v[100:103], v[164:167]
    ds_read_b128 v[36:39], v11 offset:33792
    s_waitcnt lgkmcnt(6)
    v_mfma_f32_16x16x32_bf16 v[164:167], v[212:215], v[104:107], v[164:167]
    ds_read_b128 v[40:43], v11 offset:34816
    s_waitcnt lgkmcnt(6)
    v_mfma_f32_16x16x32_bf16 v[164:167], v[216:219], v[108:111], v[164:167]
    ds_read_b128 v[44:47], v11 offset:35840
    v_cvt_pk_bf16_f32 v160, v160, v161
    v_cvt_pk_bf16_f32 v161, v162, v163
    buffer_store_dwordx2 v[160:161], v14, s[16:19], s76 offen
    s_waitcnt lgkmcnt(6)
    v_mfma_f32_16x16x32_bf16 v[164:167], v[220:223], v[112:115], v[164:167]
    ds_read_b128 v[48:51], v11 offset:38912
    s_waitcnt lgkmcnt(6)
    v_mfma_f32_16x16x32_bf16 v[164:167], v[224:227], v[116:119], v[164:167]
    ds_read_b128 v[52:55], v11 offset:39936
    s_waitcnt lgkmcnt(6)
    v_mfma_f32_16x16x32_bf16 v[164:167], v[228:231], v[120:123], v[164:167]
    ds_read_b128 v[56:59], v11 offset:41984
    s_waitcnt lgkmcnt(6)
    v_mfma_f32_16x16x32_bf16 v[168:171], v[204:207], v[32:35], v[168:171]
    ds_read_b128 v[96:99], v11 offset:47104
    s_waitcnt lgkmcnt(6)
    v_mfma_f32_16x16x32_bf16 v[168:171], v[208:211], v[36:39], v[168:171]
    ds_read_b128 v[100:103], v11 offset:48128
    s_waitcnt lgkmcnt(6)
    v_mfma_f32_16x16x32_bf16 v[168:171], v[212:215], v[40:43], v[168:171]
    ds_read_b128 v[104:107], v11 offset:49152
    s_waitcnt lgkmcnt(6)
    v_mfma_f32_16x16x32_bf16 v[168:171], v[216:219], v[44:47], v[168:171]
    ds_read_b128 v[108:111], v11 offset:50176
    v_cvt_pk_bf16_f32 v164, v164, v165
    v_cvt_pk_bf16_f32 v165, v166, v167
    buffer_store_dwordx2 v[164:165], v14, s[16:19], s77 offen
    s_waitcnt lgkmcnt(6)
    v_mfma_f32_16x16x32_bf16 v[168:171], v[220:223], v[48:51], v[168:171]
    ds_read_b128 v[112:115], v11 offset:53248
    s_waitcnt lgkmcnt(6)
    v_mfma_f32_16x16x32_bf16 v[168:171], v[224:227], v[52:55], v[168:171]
    ds_read_b128 v[116:119], v11 offset:54272
    s_waitcnt lgkmcnt(6)
    v_mfma_f32_16x16x32_bf16 v[168:171], v[228:231], v[56:59], v[168:171]
    ds_read_b128 v[120:123], v11 offset:56320
    s_waitcnt lgkmcnt(6)
    v_mfma_f32_16x16x32_bf16 v[172:175], v[204:207], v[96:99], v[172:175]
    s_waitcnt lgkmcnt(5)
    v_mfma_f32_16x16x32_bf16 v[172:175], v[208:211], v[100:103], v[172:175]
    s_waitcnt lgkmcnt(4)
    v_mfma_f32_16x16x32_bf16 v[172:175], v[212:215], v[104:107], v[172:175]
    s_waitcnt lgkmcnt(3)
    v_mfma_f32_16x16x32_bf16 v[172:175], v[216:219], v[108:111], v[172:175]
    v_cvt_pk_bf16_f32 v168, v168, v169
    v_cvt_pk_bf16_f32 v169, v170, v171
    buffer_store_dwordx2 v[168:169], v14, s[16:19], s78 offen
    s_waitcnt lgkmcnt(2)
    v_mfma_f32_16x16x32_bf16 v[172:175], v[220:223], v[112:115], v[172:175]
    s_waitcnt lgkmcnt(1)
    v_mfma_f32_16x16x32_bf16 v[172:175], v[224:227], v[116:119], v[172:175]
    s_waitcnt lgkmcnt(0)
    v_mfma_f32_16x16x32_bf16 v[172:175], v[228:231], v[120:123], v[172:175]
    s_nop 7
    s_nop 7
    v_cvt_pk_bf16_f32 v172, v172, v173
    v_cvt_pk_bf16_f32 v173, v174, v175
    buffer_store_dwordx2 v[172:173], v14, s[16:19], s79 offen
    s_waitcnt lgkmcnt(0)
    s_branch K_END
PA_W7:
    ds_read_b32 v29, v31
    s_waitcnt lgkmcnt(0)
    v_cmp_ne_u32 vcc, 0, v29
    s_nop 4
    s_cbranch_vccnz FALLBACK
    s_branch K_END
FALLBACK:
    v_mov_b32 v32, 0
    v_mov_b32 v33, 0
    v_mov_b32 v34, 0
    v_mov_b32 v35, 0
    s_lshr_b32 s35, s95, 1
    s_lshl_b32 s35, s35, 17
    s_add_u32 s35, s35, 16777216
    s_lshl_b32 s29, s27, 14
    s_add_u32 s35, s35, s29
    s_cmp_eq_u32 s24, 0
    s_cbranch_scc0 FB_NZ
    buffer_store_dwordx4 v[32:35], v13, s[20:23], s35 offen offset:0 sc0 sc1
    buffer_store_dwordx4 v[32:35], v13, s[20:23], s35 offen offset:1024 sc0 sc1
    buffer_store_dwordx4 v[32:35], v13, s[20:23], s35 offen offset:2048 sc0 sc1
    buffer_store_dwordx4 v[32:35], v13, s[20:23], s35 offen offset:3072 sc0 sc1
    s_add_u32 s35, s35, 4096
    buffer_store_dwordx4 v[32:35], v13, s[20:23], s35 offen offset:0 sc0 sc1
    buffer_store_dwordx4 v[32:35], v13, s[20:23], s35 offen offset:1024 sc0 sc1
    buffer_store_dwordx4 v[32:35], v13, s[20:23], s35 offen offset:2048 sc0 sc1
    buffer_store_dwordx4 v[32:35], v13, s[20:23], s35 offen offset:3072 sc0 sc1
    s_add_u32 s35, s35, 4096
    buffer_store_dwordx4 v[32:35], v13, s[20:23], s35 offen offset:0 sc0 sc1
    buffer_store_dwordx4 v[32:35], v13, s[20:23], s35 offen offset:1024 sc0 sc1
    buffer_store_dwordx4 v[32:35], v13, s[20:23], s35 offen offset:2048 sc0 sc1
    buffer_store_dwordx4 v[32:35], v13, s[20:23], s35 offen offset:3072 sc0 sc1
    s_add_u32 s35, s35, 4096
    buffer_store_dwordx4 v[32:35], v13, s[20:23], s35 offen offset:0 sc0 sc1
    buffer_store_dwordx4 v[32:35], v13, s[20:23], s35 offen offset:1024 sc0 sc1
    buffer_store_dwordx4 v[32:35], v13, s[20:23], s35 offen offset:2048 sc0 sc1
    buffer_store_dwordx4 v[32:35], v13, s[20:23], s35 offen offset:3072 sc0 sc1
    s_add_u32 s35, s35, 4096
FB_NZ:
    s_waitcnt vmcnt(0) lgkmcnt(0)
    s_barrier
    s_mov_b32 s96, 1
    s_mov_b32 s97, 0
    s_add_u32 s2, s95, 2
    s_and_b32 s2, s2, 255
    s_branch RESTART
K_END:
    s_endpgm
.section .rodata,"a"
.p2align 6
.amdhsa_kernel concat_heads__linear_attn_block__sliding_local_dilated__prompt_kernel
  .amdhsa_next_free_vgpr 256
  .amdhsa_next_free_sgpr 100
  .amdhsa_accum_offset 256
  .amdhsa_group_segment_fixed_size 0
  .amdhsa_kernarg_size 72
  .amdhsa_user_sgpr_count 2
  .amdhsa_user_sgpr_kernarg_segment_ptr 1
  .amdhsa_system_sgpr_workgroup_id_x 1
.end_amdhsa_kernel
```
